```python
import torch

def _softmax(x, axis=-1):
    return torch.softmax(x, dim=axis)

def _gelu(x):
    return torch.nn.functional.gelu(x, approximate='tanh')

def _silu(x):
    return torch.nn.functional.silu(x)

def _sigmoid(x):
    return torch.sigmoid(x)

def _layernorm(x, axis=-1, eps=1e-05):
    m = x.mean(dim=axis, keepdim=True)
    v = x.var(dim=axis, keepdim=True, unbiased=False)
    return (x - m) / torch.sqrt(v + eps)

def _scatter_add(tgt, idx, src, axis=0):
    return tgt.clone().index_add_(axis, idx, src)

def _segment_sum(src, seg, n):
    out = torch.zeros((n,) + src.shape[1:], dtype=src.dtype)
    return out.index_add_(0, seg, src)

def _pad(x, pw):
    flat = tuple((v for pair in reversed(pw) for v in pair))
    return torch.nn.functional.pad(x, flat)
kernel_name = 'adaLN_cond__ssm_conv_s4__glu_gated_bilinear__prompt'

def setup_inputs():

    _w = lambda a: (lambda t: t.to(torch.bfloat16) if t.is_floating_point() else t)(torch.as_tensor(a))

    def _A_setup():
        B, L, D, N = (1, 2048, 512, 128)
        A_re = -(lambda _x: torch.exp(torch.as_tensor(_x)))((lambda *s: torch.randn(*s, dtype=torch.bfloat16) * 3.2)(D, N))
        A_im = torch.pi * (lambda *s: torch.randn(*s, dtype=torch.bfloat16) * 0.1)(D, N)
        B_re = (lambda *s: torch.randn(*s, dtype=torch.bfloat16) * 0.1)(D, N)
        B_im = (lambda *s: torch.randn(*s, dtype=torch.bfloat16) * 0.1)(D, N)
        C_re = (lambda *s: torch.randn(*s, dtype=torch.bfloat16) * 0.1)(D, N)
        C_im = (lambda *s: torch.randn(*s, dtype=torch.bfloat16) * 0.1)(D, N)
        log_dt = (lambda *s: torch.randn(*s, dtype=torch.bfloat16) * 0.1)(D) * 0.5 - 4.0
        Dskip = (lambda *s: torch.randn(*s, dtype=torch.bfloat16) * 0.1)(D)
        return {'u': _w((lambda *s: torch.randn(*s, dtype=torch.bfloat16) * 0.05)(B, L, D)), 'A_re': _w(A_re), 'A_im': _w(A_im), 'B_re': _w(B_re), 'B_im': _w(B_im), 'C_re': _w(C_re), 'C_im': _w(C_im), 'log_dt': _w(log_dt), 'Dskip': _w(Dskip)}
    _A_in = _A_setup()

    def _B_setup():
        B, S, D, F = (1, 2048, 512, 1792)
        return {'x': _w((lambda *s: torch.randn(*s, dtype=torch.bfloat16) * 0.05)(B, S, D)), 'w_gate': _w((lambda *s: torch.randn(*s, dtype=torch.bfloat16) * 1.6)(D, F) * D ** (-0.5)), 'w_up': _w((lambda *s: torch.randn(*s, dtype=torch.bfloat16) * 1.6)(D, F) * D ** (-0.5)), 'w_down': _w((lambda *s: torch.randn(*s, dtype=torch.bfloat16) * 1.6)(F, D) * F ** (-0.5))}
    _B_in = _B_setup()
    return {'A_u': _A_in['u'], 'A_A_re': _A_in['A_re'], 'A_A_im': _A_in['A_im'], 'A_B_re': _A_in['B_re'], 'A_B_im': _A_in['B_im'], 'A_C_re': _A_in['C_re'], 'A_C_im': _A_in['C_im'], 'A_log_dt': _A_in['log_dt'], 'A_Dskip': _A_in['Dskip'], 'B_x': _B_in['x'], 'B_w_gate': _B_in['w_gate'], 'B_w_up': _B_in['w_up'], 'B_w_down': _B_in['w_down'], 'c': _w((lambda *s: torch.randn(*s, dtype=torch.bfloat16) * 0.2)(1, 512) * 8.0), 'w_mod': _w((lambda *s: torch.randn(*s, dtype=torch.bfloat16) * 0.2)(512, 6 * 512) * 512 ** (-0.5) * 8.0)}

def reference(A_u, A_A_re, A_A_im, A_B_re, A_B_im, A_C_re, A_C_im, A_log_dt, A_Dskip, B_x, B_w_gate, B_w_up, B_w_down, c, w_mod):

    def _A_ref(u, A_re, A_im, B_re, B_im, C_re, C_im, log_dt, Dskip):
        Bsz, L, D = u.shape
        dt = torch.exp(log_dt)[:, None]
        A = A_re + 1j * A_im
        Bc = B_re + 1j * B_im
        Cc = C_re + 1j * C_im
        logdA = dt * A
        dB = dt * Bc
        l = (lambda x, dt: x.to(dt))(torch.arange(L), A_re.dtype)
        P = torch.exp(logdA[:, :, None] * l[None, None, :])
        K = torch.einsum('dn,dnl,dn->dl', Cc, P, dB).real
        L2 = 2 * L
        Kp = _pad(K, ((0, 0), (0, L)))
        up = (lambda x, *d: x.permute(*d))(u, 0, 2, 1)
        up = _pad(up, ((0, 0), (0, 0), (0, L)))
        Kf = (lambda x, axes=(-2, -1): torch.fft.rfft2(x.float(), dim=axes))(Kp[:, None, :], axes=(-2, -1))
        Uf = (lambda x, axes=(-2, -1): torch.fft.rfft2(x.float(), dim=axes))(up[:, :, None, :], axes=(-2, -1))
        Yf = Uf * Kf[None, :, :, :]
        y = (lambda x, s, axes=(-2, -1): torch.fft.irfft2(x, s=s, dim=axes).to(torch.bfloat16))(Yf, (1, L2), axes=(-2, -1))[:, :, 0, :L]
        y = (lambda x, *d: x.permute(*d))(y, 0, 2, 1) + u * Dskip[None, None, :]
        return y

    def _B_ref(x, w_gate, w_up, w_down):
        g = torch.einsum('bsd,df->bsf', x, w_gate)
        u = torch.einsum('bsd,df->bsf', x, w_up)
        h = g * u
        return torch.einsum('bsf,fd->bsd', h, w_down)
    x = A_u
    mod = (_silu(c) @ w_mod).reshape(c.shape[0], 6, 1, -1)
    sa, ca, ga, sb, cb, gb = (mod[:, 0].clone(), mod[:, 1].clone(), mod[:, 2].clone(), mod[:, 3].clone(), mod[:, 4].clone(), mod[:, 5].clone())
    h = _layernorm(x, axis=-1) * (1 + ca) + sa
    x = x + ga * _A_ref(h, A_A_re, A_A_im, A_B_re, A_B_im, A_C_re, A_C_im, A_log_dt, A_Dskip)
    h = _layernorm(x, axis=-1) * (1 + cb) + sb
    x = x + gb * _B_ref(h, B_w_gate, B_w_up, B_w_down)
    return x
```

```asm
; @launch grid=(256,1,1) block=(512,1,1) lds=163840
.amdgcn_target "amdgcn-amd-amdhsa--gfx950"
.text
.globl adaLN_cond__ssm_conv_s4__glu_gated_bilinear__prompt_kernel
.p2align 8
.type adaLN_cond__ssm_conv_s4__glu_gated_bilinear__prompt_kernel,@function
adaLN_cond__ssm_conv_s4__glu_gated_bilinear__prompt_kernel:
    s_cmp_ge_u32 s2, 256
    s_cbranch_scc1 L_exit
    s_load_dwordx16 s[4:19], s[0:1], 0
    s_load_dwordx16 s[20:35], s[0:1], 64
    s_load_dwordx2 s[38:39], s[0:1], 136
    s_getpc_b64 s[56:57]
L_pc:
    s_lshr_b32 s50, s2, 3
    s_lshl_b32 s50, s50, 3
    v_cmp_gt_u32 vcc, 24, v0
    v_add_u32 v107, s50, v0
    s_mov_b32 m0, 163584
    v_cndmask_b32 v107, v107, v0, vcc
    v_cmp_gt_u32 vcc, 32, v0
    v_lshlrev_b32 v107, 7, v107
    v_min_u32 v107, L_exit-L_pc, v107
    s_and_saveexec_b64 s[48:49], vcc
    s_cbranch_execz L_nopf
    global_load_lds_dword v107, s[56:57]
L_nopf:
    s_mov_b64 exec, -1
    s_mov_b32 m0, 161792
    v_mov_b32 v40, 0
    v_mov_b32 v41, 0
    ds_write_addtid_b32 v40 offset:0
    v_and_b32 v99, 255, v0
    v_lshlrev_b32 v37, 4, v99
    v_add_u32 v37, lag_table-L_pc, v37
    v_lshrrev_b32 v2, 6, v0
    v_and_b32 v1, 63, v0
    v_readfirstlane_b32 s3, v2
    s_and_b32 s41, s2, 7
    s_lshr_b32 s42, s2, 3
    s_lshl_b32 s40, s41, 5
    s_add_u32 s40, s40, s42
    s_lshr_b32 s43, s3, 2
    s_and_b32 s59, s3, 3
    s_mov_b32 s58, 0
    v_mov_b32 v95, 0
    v_mov_b32 v96, 0
    s_cmp_eq_u32 s43, 0
    s_cbranch_scc0 L_else_2
    v_and_b32 v32, 1, v1
    v_lshlrev_b32 v33, 1, v1
    v_mul_u32_u24 v32, 4094, v32
    s_lshl_b32 s48, s2, 13
    s_lshl_b32 s49, s59, 8
    s_add_u32 s48, s48, s49
    v_add3_u32 v32, v32, v33, s48
    s_and_b32 s50, s2, 3
    s_lshl_b32 s51, s50, 7
    s_lshl_b32 s52, s59, 5
    s_add_u32 s51, s51, s52
    v_lshrrev_b32 v95, 3, v1
    v_add_u32 v95, s51, v95
    v_mul_u32_u24 v95, 6144, v95
    v_and_b32 v35, 7, v1
    v_lshl_add_u32 v95, v35, 4, v95
    s_lshr_b32 s51, s2, 2
    s_min_u32 s51, s51, 47
    s_lshl_b32 s51, s51, 7
    v_add_u32 v95, s51, v95
    s_lshl_b32 s50, s50, 8
    v_lshl_add_u32 v96, v1, 2, s50
    s_waitcnt lgkmcnt(0)
    global_load_dword v4, v32, s[4:5] offset:0
    global_load_dword v5, v32, s[4:5] offset:1024
    global_load_dword v6, v32, s[4:5] offset:2048
    global_load_dword v7, v32, s[4:5] offset:3072
    global_load_dword v8, v32, s[4:5] offset:128
    global_load_dword v9, v32, s[4:5] offset:1152
    global_load_dword v10, v32, s[4:5] offset:2176
    global_load_dword v11, v32, s[4:5] offset:3200
    s_branch L_end_3
L_else_2:
    s_lshl_b32 s48, s40, 9
    s_lshl_b32 s49, s59, 7
    s_add_u32 s48, s48, s49
    v_lshl_add_u32 v33, v1, 1, s48
    v_mov_b32 v100, 0
    v_mov_b32 v101, 0
    v_mov_b32 v102, 0
    v_mov_b32 v103, 0
    v_mov_b32 v104, 0
    v_mov_b32 v105, 0
    s_waitcnt lgkmcnt(0)
    global_load_short_d16_hi v100, v33, s[6:7]
    global_load_short_d16_hi v101, v33, s[8:9]
    global_load_short_d16_hi v102, v33, s[10:11]
    global_load_short_d16_hi v103, v33, s[12:13]
    global_load_short_d16_hi v104, v33, s[14:15]
    global_load_short_d16_hi v105, v33, s[16:17]
L_end_3:
    s_lshl_b32 s53, s40, 2
    s_load_dwordx2 s[44:45], s[38:39], 0
    s_load_dword s46, s[18:19], s53
    s_load_dword s47, s[20:21], s53
    s_barrier
    s_cmp_eq_u32 s43, 0
    s_cbranch_scc0 L_else_4
    s_cmp_eq_u32 s3, 3
    s_cselect_b64 exec, -1, 1
    global_load_dword v106, v96, s[30:31]
    s_cmp_lt_u32 s2, 192
    s_cselect_b64 exec, -1, 1
    s_lshl_b32 s49, s59, 12
    s_add_u32 m0, s49, 65536
    s_nop 0
    global_load_lds_dwordx4 v95, s[32:33]
    s_add_u32 m0, s49, 66560
    v_add_u32 v95, 49152, v95
    global_load_lds_dwordx4 v95, s[32:33]
    s_mov_b64 exec, -1
L_else_4:
    global_load_dwordx4 v[108:111], v37, s[56:57]
    s_and_b32 s60, s41, 1
    s_lshl_b32 s60, s60, 2
    s_and_b32 s48, s42, 3
    s_add_u32 s60, s60, s48
    s_lshr_b32 s23, s42, 2
    s_min_u32 s49, s60, 6
    s_cmp_lt_u32 s23, 7
    s_cselect_b32 s49, s23, s49
    s_lshr_b32 s61, s41, 1
    s_mul_i32 s61, s61, 7
    s_add_u32 s61, s61, s49
    s_lshl_b32 s36, s59, 11
    v_bfe_u32 v57, v1, 1, 2
    v_bfe_u32 v58, v1, 4, 1
    v_xor_b32 v57, v57, v58
    s_and_b32 s48, s59, 1
    s_lshl_b32 s48, s48, 1
    v_xor_b32 v57, s48, v57
    v_bfe_u32 v59, v0, 3, 5
    v_mul_u32_u24 v59, 3584, v59
    v_and_b32 v58, 1, v1
    v_lshl_add_u32 v59, v58, 4, v59
    s_lshl_b32 s48, s61, 7
    s_add_u32 s48, s48, 1835008
    v_add_u32 v59, s48, v59
    v_lshl_add_u32 v2, v57, 5, v59
    v_xor_b32 v3, 64, v2
    v_bfe_u32 v37, v0, 6, 1
    v_mul_u32_u24 v37, 4608, v37
    v_lshl_add_u32 v37, v1, 3, v37
    v_add_u32 v37, 131072, v37
    ds_write_b64 v37, v[40:41]
    s_mul_i32 s48, s43, 10368
    s_add_u32 s19, s48, 140288
    v_mov_b32 v37, s19
    ds_write2_b64 v37, v[40:41], v[40:41] offset0:0 offset1:1
    v_lshrrev_b32 v36, 1, v0
    v_lshlrev_b32 v36, 13, v36
    v_and_b32 v37, 1, v1
    v_lshl_add_u32 v36, v37, 4, v36
    v_and_b32 v37, 3, v1
    s_lshl_b32 s48, s40, 5
    s_add_u32 s48, s48, 1048576
    v_bfe_u32 v38, v1, 2, 2
    v_add_u32 v12, s48, v36
    v_cmp_eq_u32 vcc, 3, v38
    v_lshlrev_b32 v14, 4, v0
    s_nop 0
    v_addc_co_u32 v36, vcc, 0, v38, vcc
    v_add_u32 v14, 65536, v14
    v_add_u32 v31, 8192, v14
    v_lshlrev_b32 v36, 14, v36
    v_lshl_add_u32 v36, v37, 9, v36
    s_lshl_b32 s48, s41, 11
    s_lshl_b32 s49, s42, 4
    s_add_u32 s48, s48, s49
    s_add_u32 s48, s48, 131072
    v_add_u32 v15, s48, v36
    s_lshr_b32 s48, s41, 1
    s_lshl_b32 s48, s48, 12
    s_lshl_b32 s49, s3, 9
    s_add_u32 s48, s48, s49
    s_add_u32 s48, s48, 327680
    v_lshl_add_u32 v13, v1, 4, s48
    v_and_b32 v36, 15, v1
    v_lshrrev_b32 v37, 4, v1
    v_mul_u32_u24 v38, 544, v36
    v_lshl_add_u32 v38, v37, 4, v38
    s_lshr_b32 s48, s59, 1
    s_and_b32 s49, s59, 1
    s_mul_i32 s50, s43, 29376
    s_mul_i32 s51, s48, 8704
    s_add_u32 s50, s50, s51
    v_add_u32 v120, s50, v38
    s_mul_i32 s50, s43, 29376
    s_mul_i32 s51, s49, 8704
    s_add_u32 s50, s50, s51
    s_add_u32 s50, s50, 11968
    v_add_u32 v121, s50, v38
    s_waitcnt lgkmcnt(0)
    s_add_u32 s44, s44, 0x7f4a7c15
    s_addc_u32 s45, s45, 0x9e3779b9
    s_cmp_eq_u32 s43, 0
    s_cbranch_scc0 L_else_6
    v_bfe_u32 v38, v1, 2, 2
    v_lshl_add_u32 v38, v37, 3, v38
    v_lshlrev_b32 v38, 7, v38
    v_and_b32 v39, 3, v1
    v_lshl_add_u32 v38, v39, 3, v38
    s_lshl_b32 s50, s3, 5
    s_add_u32 s50, s50, 65536
    v_add_u32 v90, s50, v38
    v_lshlrev_b32 v91, 4, v37
    v_add_u32 v91, 162816, v91
    v_lshlrev_b32 v92, 4, v36
    v_add_u32 v92, 163072, v92
    s_lshl_b32 s48, s2, 13
    s_add_u32 s48, s48, s36
    s_add_u32 s48, s48, 1048576
    v_lshl_add_u32 v98, v1, 4, s48
    v_and_b32 v33, 1, v1
    v_lshl_add_u32 v33, v33, 2, v37
    s_lshl_b32 s48, s3, 6
    s_add_u32 s48, s48, 163072
    v_lshl_add_u32 v97, v33, 3, s48
    s_mov_b32 s50, 1065369472
    s_waitcnt vmcnt(8)
    global_store_dwordx4 v98, v[4:7], s[38:39] offset:0 sc1
    s_waitcnt vmcnt(5)
    global_store_dwordx4 v98, v[8:11], s[38:39] offset:1024 sc1
    s_cmp_lt_u32 s2, 192
    s_cselect_b64 exec, -1, 1
    s_lshl_b32 s49, s59, 12
    s_add_u32 m0, s49, 67584
    v_add_u32 v95, 49152, v95
    global_load_lds_dwordx4 v95, s[32:33]
    s_add_u32 m0, s49, 68608
    v_add_u32 v95, 49152, v95
    global_load_lds_dwordx4 v95, s[32:33]
    s_mov_b64 exec, -1
    v_dot2_f32_bf16 v36, v4, s50, 0
    v_dot2_f32_bf16 v37, v5, s50, 0
    v_dot2_f32_bf16 v38, v6, s50, 0
    v_dot2_f32_bf16 v39, v7, s50, 0
    v_dot2_f32_bf16 v40, v4, v4, 0
    v_dot2_f32_bf16 v41, v5, v5, 0
    v_dot2_f32_bf16 v42, v6, v6, 0
    v_dot2_f32_bf16 v43, v7, v7, 0
    v_dot2_f32_bf16 v36, v8, s50, v36
    v_dot2_f32_bf16 v37, v9, s50, v37
    v_dot2_f32_bf16 v38, v10, s50, v38
    v_dot2_f32_bf16 v39, v11, s50, v39
    v_dot2_f32_bf16 v40, v8, v8, v40
    v_dot2_f32_bf16 v41, v9, v9, v41
    v_dot2_f32_bf16 v42, v10, v10, v42
    v_dot2_f32_bf16 v43, v11, v11, v43
    v_permlane32_swap_b32 v36, v38
    v_permlane32_swap_b32 v37, v39
    s_lshl_b32 s48, s3, 12
    v_permlane32_swap_b32 v40, v42
    v_permlane32_swap_b32 v41, v43
    v_add_f32 v36, v36, v38
    v_add_f32 v37, v37, v39
    v_add_f32 v40, v40, v42
    v_add_f32 v41, v41, v43
    v_permlane16_swap_b32 v36, v37
    s_lshl_b32 s49, s2, 4
    v_permlane16_swap_b32 v40, v41
    v_add_f32 v36, v36, v37
    v_add_f32 v37, v40, v41
    s_add_u32 s48, s48, s49
    v_add_f32_dpp v36, v36, v36 row_ror:8 row_mask:0xf bank_mask:0xf
    v_add_f32_dpp v37, v37, v37 row_ror:8 row_mask:0xf bank_mask:0xf
    s_nop 0
    v_add_f32_dpp v36, v36, v36 row_ror:4 row_mask:0xf bank_mask:0xf
    v_add_f32_dpp v37, v37, v37 row_ror:4 row_mask:0xf bank_mask:0xf
    s_nop 0
    v_add_f32_dpp v36, v36, v36 row_ror:2 row_mask:0xf bank_mask:0xf
    v_add_f32_dpp v37, v37, v37 row_ror:2 row_mask:0xf bank_mask:0xf
    ds_write_b64 v97, v[36:37]
    s_add_u32 s48, s48, 327680
    v_mov_b32 v62, 161792
    v_mov_b32 v63, 1
    s_mov_b64 exec, 1
    ds_add_u32 v62, v63 offset:52
    s_mov_b64 exec, -1
    s_cmp_eq_u32 s3, 0
    s_cbranch_scc0 L_else_9
    v_mov_b32 v62, 161792
L_cw_11:
    ds_read_b32 v60, v62 offset:52
    s_waitcnt lgkmcnt(0)
    v_cmp_gt_u32 vcc, 4, v60
    s_cbranch_vccnz L_cw_11
    ds_read_b128 v[48:51], v92
    s_lshr_b32 s50, s2, 1
    s_lshl_b32 s50, s50, 6
    s_and_b32 s51, s2, 1
    s_lshl_b32 s51, s51, 13
    s_add_u32 s50, s50, s51
    s_add_u32 s50, s50, 65536
    v_bfrev_b32 v39, v1
    v_lshrrev_b32 v39, 30, v39
    v_lshl_add_u32 v39, v39, 4, s50
    s_mov_b32 s50, 0x3b000000
    v_mov_b32 v58, s44
    v_mov_b32 v59, s45
    s_waitcnt lgkmcnt(0)
    v_add_f32_dpp v48, v48, v48 row_ror:4 row_mask:0xf bank_mask:0xf
    v_add_f32_dpp v49, v49, v49 row_ror:4 row_mask:0xf bank_mask:0xf
    v_add_f32_dpp v50, v50, v50 row_ror:4 row_mask:0xf bank_mask:0xf
    v_add_f32_dpp v51, v51, v51 row_ror:4 row_mask:0xf bank_mask:0xf
    v_add_f32_dpp v48, v48, v48 row_ror:8 row_mask:0xf bank_mask:0xf
    v_add_f32_dpp v49, v49, v49 row_ror:8 row_mask:0xf bank_mask:0xf
    v_add_f32_dpp v50, v50, v50 row_ror:8 row_mask:0xf bank_mask:0xf
    v_add_f32_dpp v51, v51, v51 row_ror:8 row_mask:0xf bank_mask:0xf
    v_mul_f32 v52, s50, v48
    v_mul_f32 v54, s50, v49
    v_mul_f32 v53, s50, v50
    v_mul_f32 v55, s50, v51
    v_fma_f32 v54, -v52, v52, v54
    v_fma_f32 v55, -v53, v53, v55
    v_max_f32 v54, 0, v54
    v_max_f32 v55, 0, v55
    v_cvt_pk_bf16_f32 v48, v54, v55
    v_lshlrev_b32 v54, 16, v48
    v_and_b32 v55, 0xffff0000, v48
    v_add_f32 v54, 0x3727c5ac, v54
    v_add_f32 v55, 0x3727c5ac, v55
    v_cvt_pk_bf16_f32 v48, v54, v55
    v_lshlrev_b32 v54, 16, v48
    v_and_b32 v55, 0xffff0000, v48
    v_sqrt_f32 v54, v54
    v_sqrt_f32 v55, v55
    v_cvt_pk_bf16_f32 v56, v52, v54
    v_cvt_pk_bf16_f32 v57, v53, v55
    s_mov_b64 exec, 15
    global_store_dwordx4 v39, v[56:59], s[38:39] sc1
    s_mov_b64 exec, -1
    s_waitcnt vmcnt(3)
    s_branch L_end_10
L_else_9:
    s_waitcnt vmcnt(2)
L_end_10:
    v_lshl_add_u32 v52, v1, 4, s48
    v_mov_b32 v48, s44
    v_mov_b32 v49, s45
    v_mov_b32 v50, s44
    v_mov_b32 v51, s45
    s_mov_b64 exec, 1
    global_store_dwordx4 v52, v[48:51], s[38:39] sc1
    s_mov_b64 exec, -1
    s_cmp_eq_u32 s3, 3
    s_cbranch_scc0 L_else_12
    s_waitcnt vmcnt(8)
    v_lshlrev_b32 v36, 16, v106
    v_and_b32 v37, 0xffff0000, v106
    v_mul_f32 v38, 0xbfb8aa3b, v36
    v_mul_f32 v39, 0xbfb8aa3b, v37
    v_exp_f32 v38, v38
    v_exp_f32 v39, v39
    s_mov_b32 m0, 162816
    v_add_f32 v38, 1.0, v38
    v_add_f32 v39, 1.0, v39
    v_rcp_f32 v38, v38
    v_rcp_f32 v39, v39
    v_mul_f32 v36, v36, v38
    v_mul_f32 v37, v37, v39
    v_cvt_pk_bf16_f32 v36, v36, v37
    ds_write_addtid_b32 v36 offset:0
L_else_12:
    s_cmp_eq_u32 s3, 0
    s_cbranch_scc0 L_else_14
    s_waitcnt vmcnt(2)
    s_branch L_end_15
L_else_14:
    s_waitcnt vmcnt(1)
L_end_15:
    v_mov_b32 v62, 161792
    v_mov_b32 v63, 1
    s_mov_b64 exec, 1
    ds_add_u32 v62, v63 offset:48
    s_mov_b64 exec, -1
    s_cmp_lt_u32 s2, 192
    s_cbranch_scc0 L_else_16
    v_mov_b32 v62, 161792
L_cw_18:
    ds_read_b32 v60, v62 offset:48
    s_waitcnt lgkmcnt(0)
    v_cmp_gt_u32 vcc, 4, v60
    s_cbranch_vccnz L_cw_18
    ds_read_b128 v[192:195], v91 offset:0
    ds_read_b64_tr_b16 v[196:197], v90 offset:0
    ds_read_b64_tr_b16 v[198:199], v90 offset:512
    ds_read_b128 v[200:203], v91 offset:64
    ds_read_b64_tr_b16 v[204:205], v90 offset:4096
    ds_read_b64_tr_b16 v[206:207], v90 offset:4608
    ds_read_b128 v[208:211], v91 offset:128
    ds_read_b64_tr_b16 v[212:213], v90 offset:8192
    ds_read_b64_tr_b16 v[214:215], v90 offset:8704
    ds_read_b128 v[216:219], v91 offset:192
    ds_read_b64_tr_b16 v[220:221], v90 offset:12288
    ds_read_b64_tr_b16 v[222:223], v90 offset:12800
    s_waitcnt lgkmcnt(9)
    v_mfma_f32_16x16x32_bf16 v[44:47], v[192:195], v[196:199], 0
    s_waitcnt lgkmcnt(6)
    v_mfma_f32_16x16x32_bf16 v[44:47], v[200:203], v[204:207], v[44:47]
    s_waitcnt lgkmcnt(3)
    v_mfma_f32_16x16x32_bf16 v[44:47], v[208:211], v[212:215], v[44:47]
    s_waitcnt lgkmcnt(0)
    v_mfma_f32_16x16x32_bf16 v[44:47], v[216:219], v[220:223], v[44:47]
    s_lshr_b32 s50, s2, 2
    s_lshl_b32 s50, s50, 11
    s_and_b32 s51, s2, 3
    s_lshl_b32 s51, s51, 9
    s_add_u32 s50, s50, s51
    s_lshl_b32 s51, s3, 7
    s_add_u32 s50, s50, s51
    s_add_u32 s50, s50, 131072
    v_lshl_add_u32 v94, v1, 3, s50
    v_mov_b32 v58, s44
    v_mov_b32 v59, s45
    v_mov_b32 v56, v44
    v_mov_b32_dpp v57, v44 quad_perm:[1,1,3,3] row_mask:0xf bank_mask:0xf bound_ctrl:0
    s_mov_b64 exec, 0x5555
    global_store_dwordx4 v94, v[56:59], s[38:39] sc1
    s_mov_b64 exec, -1
L_else_16:
    s_bitcmp1_b32 s59, 0
    s_cselect_b32 s52, s26, s24
    s_cselect_b32 s53, s27, s25
    s_lshl_b32 s50, s42, 1
    s_lshr_b32 s51, s59, 1
    s_add_u32 s50, s50, s51
    s_mul_i32 s50, s50, 28672
    s_lshr_b32 s51, s41, 1
    s_mul_i32 s51, s51, 896
    s_add_u32 s50, s50, s51
    v_lshrrev_b32 v107, 3, v1
    v_mul_u32_u24 v107, 2560, v107
    v_lshl_add_u32 v107, v1, 7, v107
    s_mov_b32 m0, 163584
    v_add_u32 v107, s50, v107
    s_mov_b32 exec_lo, 0x7f7f7f7f
    s_mov_b32 exec_hi, 0x7f7f7f7f
    global_load_lds_dword v107, s[52:53]
    s_mov_b64 exec, -1
    s_branch L_end_7
L_else_6:
    s_lshl_b32 s48, s46, 16
    s_and_b32 s49, s46, 0xffff0000
    s_cmp_ge_u32 s59, 2
    s_cselect_b32 s48, s49, s48
    v_mov_b32 v32, 1069066811
    v_mul_f32 v32, s48, v32
    v_exp_f32 v32, v32
    s_lshr_b32 s48, s59, 1
    s_and_b32 s49, s59, 1
    s_lshl_b32 s49, s49, 8
    v_cvt_pk_bf16_f32 v32, v32, v32
    s_mul_i32 s48, s48, 29376
    s_add_u32 m0, s48, s49
    v_and_b32 v32, 0xffff0000, v32
    v_mov_b32 v44, 0x3f80
    ds_write_addtid_b32 v44 offset:11968
    s_waitcnt vmcnt(5)
    v_mul_f32 v33, v32, v100
    v_mul_f32 v34, v32, v101
    v_mul_f32 v33, 1069066811, v33
    v_mul_f32 v34, 0.15915494, v34
    v_mul_f32 v38, 0x41000000, v33
    v_mul_f32 v39, 0x41000000, v34
    v_mul_f32 v68, 0x3f800000, v33
    v_mul_f32 v69, 0x3f800000, v34
    v_mul_f32 v70, 0x43800000, v33
    v_mul_f32 v71, 0x43800000, v34
    v_exp_f32 v38, v38
    v_fract_f32 v39, v39
    v_exp_f32 v68, v68
    v_fract_f32 v69, v69
    v_exp_f32 v70, v70
    v_fract_f32 v71, v71
    v_cos_f32 v36, v39
    v_sin_f32 v37, v39
    v_cos_f32 v64, v69
    v_sin_f32 v65, v69
    v_cos_f32 v66, v71
    v_sin_f32 v67, v71
    s_waitcnt vmcnt(1)
    v_mul_f32 v102, v32, v102
    v_mul_f32 v103, v32, v103
    v_pk_mul_f32 v[36:37], v[36:37], v[38:39] op_sel:[0,0] op_sel_hi:[1,0]
    v_pk_mul_f32 v[64:65], v[64:65], v[68:69] op_sel:[0,0] op_sel_hi:[1,0]
    v_pk_mul_f32 v[66:67], v[66:67], v[70:71] op_sel:[0,0] op_sel_hi:[1,0]
    s_cmp_lt_u32 s2, 224
    s_cbranch_scc0 L_else_20
    v_lshrrev_b32 v76, 5, v1
    v_lshlrev_b32 v76, 13, v76
    v_and_b32 v77, 31, v1
    v_lshl_add_u32 v76, v77, 2, v76
    s_lshl_b32 s50, s42, 16
    s_lshl_b32 s51, s59, 14
    s_add_u32 s50, s50, s51
    s_lshl_b32 s51, s41, 7
    s_add_u32 s50, s50, s51
    v_add_u32 v76, s50, v76
    v_add_u32 v77, 4096, v76
    global_load_dword v112, v76, s[28:29] offset:0
    global_load_dword v113, v76, s[28:29] offset:1024
    global_load_dword v114, v76, s[28:29] offset:2048
    global_load_dword v115, v76, s[28:29] offset:3072
    global_load_dword v116, v77, s[28:29] offset:0
    global_load_dword v117, v77, s[28:29] offset:1024
    global_load_dword v118, v77, s[28:29] offset:2048
    global_load_dword v119, v77, s[28:29] offset:3072
L_else_20:
    v_pk_mul_f32 v[38:39], v[36:37], v[36:37] op_sel:[0,0] op_sel_hi:[0,1]
    v_pk_mul_f32 v[68:69], v[104:105], v[102:103] op_sel:[0,0] op_sel_hi:[0,1]
    v_cvt_pk_bf16_f32 v45, v36, v37
    v_pk_fma_f32 v[48:49], v[104:105], v[102:103], v[68:69] op_sel:[1,1,0] op_sel_hi:[1,0,1] neg_lo:[1,0,0]
    v_pk_fma_f32 v[42:43], v[36:37], v[36:37], v[38:39] op_sel:[1,1,0] op_sel_hi:[1,0,1] neg_lo:[1,0,0]
    ds_write_addtid_b32 v45 offset:12512
    v_cvt_pk_bf16_f32 v46, v48, -v49
    v_pk_mul_f32 v[38:39], v[42:43], v[36:37] op_sel:[0,0] op_sel_hi:[0,1]
    ds_write_addtid_b32 v46 offset:0
    v_cvt_pk_bf16_f32 v44, v42, v43
    v_pk_fma_f32 v[40:41], v[42:43], v[36:37], v[38:39] op_sel:[1,1,0] op_sel_hi:[1,0,1] neg_lo:[1,0,0]
    v_pk_mul_f32 v[68:69], v[48:49], v[64:65] op_sel:[0,0] op_sel_hi:[0,1]
    ds_write_addtid_b32 v44 offset:13056
    v_pk_fma_f32 v[50:51], v[48:49], v[64:65], v[68:69] op_sel:[1,1,0] op_sel_hi:[1,0,1] neg_lo:[1,0,0]
    v_pk_mul_f32 v[38:39], v[40:41], v[36:37] op_sel:[0,0] op_sel_hi:[0,1]
    v_cvt_pk_bf16_f32 v45, v40, v41
    v_cvt_pk_bf16_f32 v47, v50, -v51
    v_pk_fma_f32 v[42:43], v[40:41], v[36:37], v[38:39] op_sel:[1,1,0] op_sel_hi:[1,0,1] neg_lo:[1,0,0]
    ds_write_addtid_b32 v47 offset:544
    ds_write_addtid_b32 v45 offset:13600
    v_pk_mul_f32 v[38:39], v[42:43], v[36:37] op_sel:[0,0] op_sel_hi:[0,1]
    v_pk_mul_f32 v[68:69], v[50:51], v[64:65] op_sel:[0,0] op_sel_hi:[0,1]
    v_cvt_pk_bf16_f32 v44, v42, v43
    v_pk_fma_f32 v[52:53], v[50:51], v[64:65], v[68:69] op_sel:[1,1,0] op_sel_hi:[1,0,1] neg_lo:[1,0,0]
    v_pk_fma_f32 v[40:41], v[42:43], v[36:37], v[38:39] op_sel:[1,1,0] op_sel_hi:[1,0,1] neg_lo:[1,0,0]
    ds_write_addtid_b32 v44 offset:14144
    v_cvt_pk_bf16_f32 v46, v52, -v53
    v_pk_mul_f32 v[38:39], v[40:41], v[36:37] op_sel:[0,0] op_sel_hi:[0,1]
    ds_write_addtid_b32 v46 offset:1088
    v_cvt_pk_bf16_f32 v45, v40, v41
    v_pk_fma_f32 v[42:43], v[40:41], v[36:37], v[38:39] op_sel:[1,1,0] op_sel_hi:[1,0,1] neg_lo:[1,0,0]
    v_pk_mul_f32 v[68:69], v[52:53], v[64:65] op_sel:[0,0] op_sel_hi:[0,1]
    ds_write_addtid_b32 v45 offset:14688
    v_pk_fma_f32 v[54:55], v[52:53], v[64:65], v[68:69] op_sel:[1,1,0] op_sel_hi:[1,0,1] neg_lo:[1,0,0]
    v_pk_mul_f32 v[38:39], v[42:43], v[36:37] op_sel:[0,0] op_sel_hi:[0,1]
    v_cvt_pk_bf16_f32 v44, v42, v43
    v_cvt_pk_bf16_f32 v47, v54, -v55
    v_pk_fma_f32 v[40:41], v[42:43], v[36:37], v[38:39] op_sel:[1,1,0] op_sel_hi:[1,0,1] neg_lo:[1,0,0]
    ds_write_addtid_b32 v47 offset:1632
    ds_write_addtid_b32 v44 offset:15232
    v_pk_mul_f32 v[38:39], v[40:41], v[36:37] op_sel:[0,0] op_sel_hi:[0,1]
    v_pk_mul_f32 v[68:69], v[54:55], v[64:65] op_sel:[0,0] op_sel_hi:[0,1]
    v_cvt_pk_bf16_f32 v45, v40, v41
    v_pk_fma_f32 v[56:57], v[54:55], v[64:65], v[68:69] op_sel:[1,1,0] op_sel_hi:[1,0,1] neg_lo:[1,0,0]
    v_pk_fma_f32 v[42:43], v[40:41], v[36:37], v[38:39] op_sel:[1,1,0] op_sel_hi:[1,0,1] neg_lo:[1,0,0]
    ds_write_addtid_b32 v45 offset:15776
    v_cvt_pk_bf16_f32 v46, v56, -v57
    v_pk_mul_f32 v[38:39], v[42:43], v[36:37] op_sel:[0,0] op_sel_hi:[0,1]
    ds_write_addtid_b32 v46 offset:2176
    v_cvt_pk_bf16_f32 v44, v42, v43
    v_pk_fma_f32 v[40:41], v[42:43], v[36:37], v[38:39] op_sel:[1,1,0] op_sel_hi:[1,0,1] neg_lo:[1,0,0]
    v_pk_mul_f32 v[68:69], v[56:57], v[64:65] op_sel:[0,0] op_sel_hi:[0,1]
    ds_write_addtid_b32 v44 offset:16320
    v_pk_fma_f32 v[58:59], v[56:57], v[64:65], v[68:69] op_sel:[1,1,0] op_sel_hi:[1,0,1] neg_lo:[1,0,0]
    v_pk_mul_f32 v[38:39], v[40:41], v[36:37] op_sel:[0,0] op_sel_hi:[0,1]
    v_cvt_pk_bf16_f32 v45, v40, v41
    v_cvt_pk_bf16_f32 v47, v58, -v59
    v_pk_fma_f32 v[42:43], v[40:41], v[36:37], v[38:39] op_sel:[1,1,0] op_sel_hi:[1,0,1] neg_lo:[1,0,0]
    ds_write_addtid_b32 v47 offset:2720
    ds_write_addtid_b32 v45 offset:16864
    v_pk_mul_f32 v[38:39], v[42:43], v[36:37] op_sel:[0,0] op_sel_hi:[0,1]
    v_pk_mul_f32 v[68:69], v[58:59], v[64:65] op_sel:[0,0] op_sel_hi:[0,1]
    v_cvt_pk_bf16_f32 v44, v42, v43
    v_pk_fma_f32 v[60:61], v[58:59], v[64:65], v[68:69] op_sel:[1,1,0] op_sel_hi:[1,0,1] neg_lo:[1,0,0]
    v_pk_fma_f32 v[40:41], v[42:43], v[36:37], v[38:39] op_sel:[1,1,0] op_sel_hi:[1,0,1] neg_lo:[1,0,0]
    ds_write_addtid_b32 v44 offset:17408
    v_cvt_pk_bf16_f32 v46, v60, -v61
    v_pk_mul_f32 v[38:39], v[40:41], v[36:37] op_sel:[0,0] op_sel_hi:[0,1]
    ds_write_addtid_b32 v46 offset:3264
    v_cvt_pk_bf16_f32 v45, v40, v41
    v_pk_fma_f32 v[42:43], v[40:41], v[36:37], v[38:39] op_sel:[1,1,0] op_sel_hi:[1,0,1] neg_lo:[1,0,0]
    v_pk_mul_f32 v[68:69], v[60:61], v[64:65] op_sel:[0,0] op_sel_hi:[0,1]
    ds_write_addtid_b32 v45 offset:17952
    v_pk_fma_f32 v[62:63], v[60:61], v[64:65], v[68:69] op_sel:[1,1,0] op_sel_hi:[1,0,1] neg_lo:[1,0,0]
    v_pk_mul_f32 v[38:39], v[42:43], v[36:37] op_sel:[0,0] op_sel_hi:[0,1]
    v_cvt_pk_bf16_f32 v44, v42, v43
    v_cvt_pk_bf16_f32 v47, v62, -v63
    v_pk_fma_f32 v[40:41], v[42:43], v[36:37], v[38:39] op_sel:[1,1,0] op_sel_hi:[1,0,1] neg_lo:[1,0,0]
    ds_write_addtid_b32 v47 offset:3808
    ds_write_addtid_b32 v44 offset:18496
    v_pk_mul_f32 v[38:39], v[40:41], v[36:37] op_sel:[0,0] op_sel_hi:[0,1]
    v_pk_mul_f32 v[68:69], v[48:49], v[66:67] op_sel:[0,0] op_sel_hi:[0,1]
    v_cvt_pk_bf16_f32 v45, v40, v41
    v_pk_fma_f32 v[50:51], v[48:49], v[66:67], v[68:69] op_sel:[1,1,0] op_sel_hi:[1,0,1] neg_lo:[1,0,0]
    v_pk_fma_f32 v[42:43], v[40:41], v[36:37], v[38:39] op_sel:[1,1,0] op_sel_hi:[1,0,1] neg_lo:[1,0,0]
    ds_write_addtid_b32 v45 offset:19040
    v_cvt_pk_bf16_f32 v46, v50, -v51
    v_pk_mul_f32 v[38:39], v[42:43], v[36:37] op_sel:[0,0] op_sel_hi:[0,1]
    ds_write_addtid_b32 v46 offset:4352
    v_cvt_pk_bf16_f32 v44, v42, v43
    v_pk_fma_f32 v[40:41], v[42:43], v[36:37], v[38:39] op_sel:[1,1,0] op_sel_hi:[1,0,1] neg_lo:[1,0,0]
    v_pk_mul_f32 v[68:69], v[52:53], v[66:67] op_sel:[0,0] op_sel_hi:[0,1]
    ds_write_addtid_b32 v44 offset:19584
    v_pk_fma_f32 v[54:55], v[52:53], v[66:67], v[68:69] op_sel:[1,1,0] op_sel_hi:[1,0,1] neg_lo:[1,0,0]
    v_pk_mul_f32 v[38:39], v[40:41], v[36:37] op_sel:[0,0] op_sel_hi:[0,1]
    v_cvt_pk_bf16_f32 v45, v40, v41
    v_cvt_pk_bf16_f32 v47, v54, -v55
    v_pk_fma_f32 v[42:43], v[40:41], v[36:37], v[38:39] op_sel:[1,1,0] op_sel_hi:[1,0,1] neg_lo:[1,0,0]
    ds_write_addtid_b32 v47 offset:4896
    ds_write_addtid_b32 v45 offset:20128
    v_pk_mul_f32 v[38:39], v[42:43], v[36:37] op_sel:[0,0] op_sel_hi:[0,1]
    v_pk_mul_f32 v[68:69], v[56:57], v[66:67] op_sel:[0,0] op_sel_hi:[0,1]
    v_cvt_pk_bf16_f32 v44, v42, v43
    v_pk_fma_f32 v[58:59], v[56:57], v[66:67], v[68:69] op_sel:[1,1,0] op_sel_hi:[1,0,1] neg_lo:[1,0,0]
    v_pk_fma_f32 v[40:41], v[42:43], v[36:37], v[38:39] op_sel:[1,1,0] op_sel_hi:[1,0,1] neg_lo:[1,0,0]
    ds_write_addtid_b32 v44 offset:20672
    v_cvt_pk_bf16_f32 v46, v58, -v59
    v_pk_mul_f32 v[38:39], v[40:41], v[36:37] op_sel:[0,0] op_sel_hi:[0,1]
    ds_write_addtid_b32 v46 offset:5440
    v_cvt_pk_bf16_f32 v45, v40, v41
    v_pk_fma_f32 v[42:43], v[40:41], v[36:37], v[38:39] op_sel:[1,1,0] op_sel_hi:[1,0,1] neg_lo:[1,0,0]
    v_pk_mul_f32 v[68:69], v[60:61], v[66:67] op_sel:[0,0] op_sel_hi:[0,1]
    ds_write_addtid_b32 v45 offset:21216
    v_pk_fma_f32 v[62:63], v[60:61], v[66:67], v[68:69] op_sel:[1,1,0] op_sel_hi:[1,0,1] neg_lo:[1,0,0]
    v_pk_mul_f32 v[38:39], v[42:43], v[36:37] op_sel:[0,0] op_sel_hi:[0,1]
    v_cvt_pk_bf16_f32 v44, v42, v43
    v_cvt_pk_bf16_f32 v47, v62, -v63
    v_pk_fma_f32 v[40:41], v[42:43], v[36:37], v[38:39] op_sel:[1,1,0] op_sel_hi:[1,0,1] neg_lo:[1,0,0]
    ds_write_addtid_b32 v47 offset:5984
    ds_write_addtid_b32 v44 offset:21760
    v_pk_mul_f32 v[38:39], v[40:41], v[36:37] op_sel:[0,0] op_sel_hi:[0,1]
    v_pk_mul_f32 v[68:69], v[58:59], v[66:67] op_sel:[0,0] op_sel_hi:[0,1]
    v_cvt_pk_bf16_f32 v45, v40, v41
    v_pk_fma_f32 v[56:57], v[58:59], v[66:67], v[68:69] op_sel:[1,1,0] op_sel_hi:[1,0,1] neg_lo:[1,0,0]
    v_pk_fma_f32 v[42:43], v[40:41], v[36:37], v[38:39] op_sel:[1,1,0] op_sel_hi:[1,0,1] neg_lo:[1,0,0]
    ds_write_addtid_b32 v45 offset:22304
    v_cvt_pk_bf16_f32 v46, v56, -v57
    v_pk_mul_f32 v[38:39], v[42:43], v[36:37] op_sel:[0,0] op_sel_hi:[0,1]
    ds_write_addtid_b32 v46 offset:10880
    v_cvt_pk_bf16_f32 v44, v42, v43
    v_pk_fma_f32 v[40:41], v[42:43], v[36:37], v[38:39] op_sel:[1,1,0] op_sel_hi:[1,0,1] neg_lo:[1,0,0]
    v_pk_mul_f32 v[68:69], v[56:57], v[66:67] op_sel:[0,0] op_sel_hi:[0,1]
    ds_write_addtid_b32 v44 offset:22848
    v_pk_fma_f32 v[58:59], v[56:57], v[66:67], v[68:69] op_sel:[1,1,0] op_sel_hi:[1,0,1] neg_lo:[1,0,0]
    v_pk_mul_f32 v[38:39], v[40:41], v[36:37] op_sel:[0,0] op_sel_hi:[0,1]
    v_cvt_pk_bf16_f32 v45, v40, v41
    v_cvt_pk_bf16_f32 v47, v58, -v59
    v_pk_fma_f32 v[42:43], v[40:41], v[36:37], v[38:39] op_sel:[1,1,0] op_sel_hi:[1,0,1] neg_lo:[1,0,0]
    ds_write_addtid_b32 v47 offset:11424
    ds_write_addtid_b32 v45 offset:23392
    v_pk_mul_f32 v[38:39], v[42:43], v[36:37] op_sel:[0,0] op_sel_hi:[0,1]
    v_pk_mul_f32 v[68:69], v[50:51], v[66:67] op_sel:[0,0] op_sel_hi:[0,1]
    v_cvt_pk_bf16_f32 v44, v42, v43
    v_pk_fma_f32 v[48:49], v[50:51], v[66:67], v[68:69] op_sel:[1,1,0] op_sel_hi:[1,0,1] neg_lo:[1,0,0]
    v_pk_fma_f32 v[40:41], v[42:43], v[36:37], v[38:39] op_sel:[1,1,0] op_sel_hi:[1,0,1] neg_lo:[1,0,0]
    ds_write_addtid_b32 v44 offset:23936
    v_cvt_pk_bf16_f32 v46, v48, -v49
    v_pk_mul_f32 v[38:39], v[40:41], v[36:37] op_sel:[0,0] op_sel_hi:[0,1]
    ds_write_addtid_b32 v46 offset:6528
    v_cvt_pk_bf16_f32 v45, v40, v41
    v_pk_fma_f32 v[42:43], v[40:41], v[36:37], v[38:39] op_sel:[1,1,0] op_sel_hi:[1,0,1] neg_lo:[1,0,0]
    v_pk_mul_f32 v[68:69], v[48:49], v[66:67] op_sel:[0,0] op_sel_hi:[0,1]
    ds_write_addtid_b32 v45 offset:24480
    v_pk_fma_f32 v[50:51], v[48:49], v[66:67], v[68:69] op_sel:[1,1,0] op_sel_hi:[1,0,1] neg_lo:[1,0,0]
    v_pk_mul_f32 v[38:39], v[42:43], v[36:37] op_sel:[0,0] op_sel_hi:[0,1]
    v_cvt_pk_bf16_f32 v44, v42, v43
    v_cvt_pk_bf16_f32 v47, v50, -v51
    v_pk_fma_f32 v[40:41], v[42:43], v[36:37], v[38:39] op_sel:[1,1,0] op_sel_hi:[1,0,1] neg_lo:[1,0,0]
    ds_write_addtid_b32 v47 offset:7072
    ds_write_addtid_b32 v44 offset:25024
    v_pk_mul_f32 v[38:39], v[40:41], v[36:37] op_sel:[0,0] op_sel_hi:[0,1]
    v_pk_mul_f32 v[68:69], v[50:51], v[66:67] op_sel:[0,0] op_sel_hi:[0,1]
    v_cvt_pk_bf16_f32 v45, v40, v41
    v_pk_fma_f32 v[48:49], v[50:51], v[66:67], v[68:69] op_sel:[1,1,0] op_sel_hi:[1,0,1] neg_lo:[1,0,0]
    v_pk_fma_f32 v[42:43], v[40:41], v[36:37], v[38:39] op_sel:[1,1,0] op_sel_hi:[1,0,1] neg_lo:[1,0,0]
    ds_write_addtid_b32 v45 offset:25568
    v_cvt_pk_bf16_f32 v46, v48, -v49
    v_pk_mul_f32 v[38:39], v[42:43], v[36:37] op_sel:[0,0] op_sel_hi:[0,1]
    ds_write_addtid_b32 v46 offset:7616
    v_cvt_pk_bf16_f32 v44, v42, v43
    v_pk_fma_f32 v[40:41], v[42:43], v[36:37], v[38:39] op_sel:[1,1,0] op_sel_hi:[1,0,1] neg_lo:[1,0,0]
    v_pk_mul_f32 v[68:69], v[48:49], v[66:67] op_sel:[0,0] op_sel_hi:[0,1]
    ds_write_addtid_b32 v44 offset:26112
    v_pk_fma_f32 v[50:51], v[48:49], v[66:67], v[68:69] op_sel:[1,1,0] op_sel_hi:[1,0,1] neg_lo:[1,0,0]
    v_pk_mul_f32 v[38:39], v[40:41], v[36:37] op_sel:[0,0] op_sel_hi:[0,1]
    v_cvt_pk_bf16_f32 v45, v40, v41
    v_cvt_pk_bf16_f32 v47, v50, -v51
    v_pk_fma_f32 v[42:43], v[40:41], v[36:37], v[38:39] op_sel:[1,1,0] op_sel_hi:[1,0,1] neg_lo:[1,0,0]
    ds_write_addtid_b32 v47 offset:8160
    ds_write_addtid_b32 v45 offset:26656
    v_pk_mul_f32 v[38:39], v[42:43], v[36:37] op_sel:[0,0] op_sel_hi:[0,1]
    ds_write_addtid_b32 v47 offset:8704
    v_cvt_pk_bf16_f32 v44, v42, v43
    v_pk_mul_f32 v[68:69], v[50:51], v[66:67] op_sel:[0,0] op_sel_hi:[0,1]
    v_pk_fma_f32 v[40:41], v[42:43], v[36:37], v[38:39] op_sel:[1,1,0] op_sel_hi:[1,0,1] neg_lo:[1,0,0]
    ds_write_addtid_b32 v44 offset:27200
    v_pk_fma_f32 v[48:49], v[50:51], v[66:67], v[68:69] op_sel:[1,1,0] op_sel_hi:[1,0,1] neg_lo:[1,0,0]
    v_pk_mul_f32 v[38:39], v[40:41], v[36:37] op_sel:[0,0] op_sel_hi:[0,1]
    v_cvt_pk_bf16_f32 v46, v48, -v49
    v_cvt_pk_bf16_f32 v45, v40, v41
    v_pk_fma_f32 v[42:43], v[40:41], v[36:37], v[38:39] op_sel:[1,1,0] op_sel_hi:[1,0,1] neg_lo:[1,0,0]
    ds_write_addtid_b32 v46 offset:9248
    ds_write_addtid_b32 v45 offset:27744
    v_pk_mul_f32 v[68:69], v[48:49], v[66:67] op_sel:[0,0] op_sel_hi:[0,1]
    v_pk_mul_f32 v[38:39], v[42:43], v[36:37] op_sel:[0,0] op_sel_hi:[0,1]
    v_cvt_pk_bf16_f32 v44, v42, v43
    v_pk_fma_f32 v[50:51], v[48:49], v[66:67], v[68:69] op_sel:[1,1,0] op_sel_hi:[1,0,1] neg_lo:[1,0,0]
    v_pk_fma_f32 v[40:41], v[42:43], v[36:37], v[38:39] op_sel:[1,1,0] op_sel_hi:[1,0,1] neg_lo:[1,0,0]
    v_cvt_pk_bf16_f32 v47, v50, -v51
    ds_write_addtid_b32 v44 offset:28288
    v_cvt_pk_bf16_f32 v45, v40, v41
    ds_write_addtid_b32 v47 offset:9792
    ds_write_addtid_b32 v45 offset:28832
    v_pk_mul_f32 v[68:69], v[50:51], v[66:67] op_sel:[0,0] op_sel_hi:[0,1]
    v_pk_fma_f32 v[48:49], v[50:51], v[66:67], v[68:69] op_sel:[1,1,0] op_sel_hi:[1,0,1] neg_lo:[1,0,0]
    v_cvt_pk_bf16_f32 v46, v48, -v49
    ds_write_addtid_b32 v46 offset:10336
    s_cmp_lt_u32 s2, 224
    s_cbranch_scc0 L_else_22
    s_waitcnt vmcnt(8)
    s_branch L_end_23
L_else_22:
    s_waitcnt vmcnt(0)
L_end_23:
L_end_7:
    s_waitcnt lgkmcnt(0)
    s_barrier
    ds_read_b128 v[128:131], v120 offset:0
    ds_read_b128 v[132:135], v121 offset:0
    ds_read_b128 v[136:139], v120 offset:64
    ds_read_b128 v[140:143], v121 offset:64
    ds_read_b128 v[144:147], v120 offset:128
    ds_read_b128 v[148:151], v121 offset:128
    ds_read_b128 v[152:155], v120 offset:192
    ds_read_b128 v[156:159], v121 offset:192
    ds_read_b128 v[160:163], v120 offset:256
    ds_read_b128 v[164:167], v121 offset:256
    ds_read_b128 v[168:171], v120 offset:320
    ds_read_b128 v[172:175], v121 offset:320
    ds_read_b128 v[176:179], v120 offset:384
    ds_read_b128 v[180:183], v121 offset:384
    ds_read_b128 v[184:187], v120 offset:448
    ds_read_b128 v[188:191], v121 offset:448
    v_add_u32_sdwa v122, s19, v111 dst_sel:DWORD dst_unused:UNUSED_PAD src0_sel:DWORD src1_sel:WORD_0
    v_mul_u32_u24 v36, 36, v99
    v_add_u32_sdwa v123, v122, v111 dst_sel:DWORD dst_unused:UNUSED_PAD src0_sel:DWORD src1_sel:WORD_1
    s_add_u32 s50, s19, 9176
    v_add_u32_sdwa v124, v123, v111 dst_sel:DWORD dst_unused:UNUSED_PAD src0_sel:DWORD src1_sel:WORD_1
    v_sub_u32 v36, s50, v36
    v_add_u32_sdwa v125, v124, v111 dst_sel:DWORD dst_unused:UNUSED_PAD src0_sel:DWORD src1_sel:WORD_1
    s_waitcnt lgkmcnt(14)
    v_mfma_f32_16x16x32_bf16 v[40:43], v[128:131], v[132:135], 0
    s_and_b32 s48, s42, 3
    s_lshl_b32 s22, s41, 2
    s_waitcnt lgkmcnt(12)
    v_mfma_f32_16x16x32_bf16 v[40:43], v[136:139], v[140:143], v[40:43]
    s_add_u32 s22, s22, s48
    s_lshl_b32 s63, s43, 5
    s_waitcnt lgkmcnt(10)
    v_mfma_f32_16x16x32_bf16 v[40:43], v[144:147], v[148:151], v[40:43]
    s_lshl_b32 s48, s60, 2
    s_add_u32 s48, s48, s59
    s_waitcnt lgkmcnt(8)
    v_mfma_f32_16x16x32_bf16 v[40:43], v[152:155], v[156:159], v[40:43]
    s_cmp_lt_u32 s2, 224
    s_cselect_b32 s48, s48, s22
    s_waitcnt lgkmcnt(6)
    v_mfma_f32_16x16x32_bf16 v[40:43], v[160:163], v[164:167], v[40:43]
    s_add_u32 s63, s63, s48
    s_mul_i32 s62, s3, 7
    s_waitcnt lgkmcnt(4)
    v_mfma_f32_16x16x32_bf16 v[40:43], v[168:171], v[172:175], v[40:43]
    s_lshr_b32 s62, s62, 1
    s_mul_i32 s48, s43, 16640
    s_waitcnt lgkmcnt(2)
    v_mfma_f32_16x16x32_bf16 v[40:43], v[176:179], v[180:183], v[40:43]
    v_lshl_add_u32 v126, v99, 4, s48
    v_add_u32_sdwa v64, v36, v108 dst_sel:DWORD dst_unused:UNUSED_PAD src0_sel:DWORD src1_sel:BYTE_0
    s_waitcnt lgkmcnt(0)
    v_mfma_f32_16x16x32_bf16 v[40:43], v[184:187], v[188:191], v[40:43]
    v_add_u32_sdwa v65, v36, v108 dst_sel:DWORD dst_unused:UNUSED_PAD src0_sel:DWORD src1_sel:BYTE_1
    v_add_u32_sdwa v66, v36, v108 dst_sel:DWORD dst_unused:UNUSED_PAD src0_sel:DWORD src1_sel:BYTE_2
    v_add_u32_sdwa v67, v36, v108 dst_sel:DWORD dst_unused:UNUSED_PAD src0_sel:DWORD src1_sel:BYTE_3
    v_add_u32_sdwa v68, v36, v109 dst_sel:DWORD dst_unused:UNUSED_PAD src0_sel:DWORD src1_sel:BYTE_0
    v_add_u32_sdwa v69, v36, v109 dst_sel:DWORD dst_unused:UNUSED_PAD src0_sel:DWORD src1_sel:BYTE_1
    v_add_u32_sdwa v70, v36, v109 dst_sel:DWORD dst_unused:UNUSED_PAD src0_sel:DWORD src1_sel:BYTE_2
    v_add_u32_sdwa v71, v36, v109 dst_sel:DWORD dst_unused:UNUSED_PAD src0_sel:DWORD src1_sel:BYTE_3
    v_add_u32_sdwa v72, v36, v110 dst_sel:DWORD dst_unused:UNUSED_PAD src0_sel:DWORD src1_sel:BYTE_0
    v_add_u32_sdwa v73, v36, v110 dst_sel:DWORD dst_unused:UNUSED_PAD src0_sel:DWORD src1_sel:BYTE_1
    v_add_u32_sdwa v74, v36, v110 dst_sel:DWORD dst_unused:UNUSED_PAD src0_sel:DWORD src1_sel:BYTE_2
    ds_write_b32 v122, v40
    ds_write_b32 v123, v41
    ds_write_b32 v124, v42
    ds_write_b32 v125, v43
    s_waitcnt lgkmcnt(0)
    s_barrier
    ds_read_b32 v64, v64
    ds_read_b32 v65, v65
    ds_read_b32 v66, v66
    ds_read_b32 v67, v67
    ds_read_b32 v68, v68
    ds_read_b32 v69, v69
    ds_read_b32 v70, v70
    ds_read_b32 v71, v71
    ds_read_b32 v72, v72
    ds_read_b32 v73, v73
    ds_read_b32 v74, v74
    s_mov_b32 exec_hi, 0
    global_load_dwordx2 v[32:33], v13, s[38:39] sc1
    s_mov_b32 exec_hi, -1
    v_lshrrev_b32 v76, 3, v1
    v_mul_u32_u24 v76, 4128, v76
    v_lshl_add_u32 v76, v1, 2, v76
    v_mov_b32 v77, 0
    v_and_b32 v57, 3, v1
    v_bfe_u32 v58, v1, 2, 2
    v_mul_u32_u24 v56, 4160, v57
    v_lshrrev_b32 v57, 4, v1
    v_lshl_add_u32 v56, v57, 4, v56
    v_lshlrev_b32 v58, 3, v58
    v_sub_u32 v56, v56, v58
    s_lshr_b32 s48, s59, 1
    s_and_b32 s49, s59, 1
    s_lshl_b32 s49, s49, 8
    s_mul_i32 s50, s48, 16640
    s_sub_u32 s50, s50, s49
    s_add_u32 s50, s50, 280
    v_add_u32 v24, s50, v56
    s_cmp_eq_u32 s3, 7
    s_cbranch_scc0 L_else_26
    ds_write_b32 v76, v77 offset:4096
L_else_26:
    s_cmp_eq_u32 s43, 1
    s_cbranch_scc0 L_else_28
    s_add_u32 m0, s36, 122880
    v_subrev_u32 v2, 114688, v2
    global_load_lds_dwordx4 v2, s[24:25]
    s_add_u32 m0, s36, 123904
    v_subrev_u32 v3, 114688, v3
    global_load_lds_dwordx4 v3, s[26:27]
    s_add_u32 m0, s36, 114688
    v_subrev_u32 v2, 114688, v2
    global_load_lds_dwordx4 v2, s[24:25]
    s_add_u32 m0, s36, 115712
    v_subrev_u32 v3, 114688, v3
    global_load_lds_dwordx4 v3, s[26:27]
    s_add_u32 m0, s36, 106496
    v_subrev_u32 v2, 114688, v2
    global_load_lds_dwordx4 v2, s[24:25]
    s_add_u32 m0, s36, 107520
    v_subrev_u32 v3, 114688, v3
    global_load_lds_dwordx4 v3, s[26:27]
    s_add_u32 m0, s36, 98304
    v_subrev_u32 v2, 114688, v2
    global_load_lds_dwordx4 v2, s[24:25]
    s_add_u32 m0, s36, 99328
    v_subrev_u32 v3, 114688, v3
    global_load_lds_dwordx4 v3, s[26:27]
L_else_28:
    s_waitcnt lgkmcnt(0)
    v_cvt_pk_bf16_f32 v80, v71, v70
    v_cvt_pk_bf16_f32 v81, v69, v68
    v_cvt_pk_bf16_f32 v82, v67, v66
    v_cvt_pk_bf16_f32 v83, v65, v64
    ds_write_b128 v126, v[80:83] offset:0
    v_cvt_pk_bf16_f32 v84, v72, v71
    v_cvt_pk_bf16_f32 v85, v70, v69
    v_cvt_pk_bf16_f32 v86, v68, v67
    v_cvt_pk_bf16_f32 v87, v66, v65
    ds_write_b128 v126, v[84:87] offset:4160
    v_cvt_pk_bf16_f32 v88, v73, v72
    v_cvt_pk_bf16_f32 v89, v71, v70
    v_cvt_pk_bf16_f32 v90, v69, v68
    v_cvt_pk_bf16_f32 v91, v67, v66
    ds_write_b128 v126, v[88:91] offset:8320
    v_cvt_pk_bf16_f32 v92, v74, v73
    v_cvt_pk_bf16_f32 v93, v72, v71
    v_cvt_pk_bf16_f32 v94, v70, v69
    v_cvt_pk_bf16_f32 v95, v68, v67
    ds_write_b128 v126, v[92:95] offset:12480
    s_cmp_eq_u32 s43, 1
    s_cbranch_scc0 L_else_30
    s_add_u32 m0, s36, 90112
    v_subrev_u32 v2, 114688, v2
    global_load_lds_dwordx4 v2, s[24:25]
    s_add_u32 m0, s36, 91136
    v_subrev_u32 v3, 114688, v3
    global_load_lds_dwordx4 v3, s[26:27]
    s_add_u32 m0, s36, 81920
    v_subrev_u32 v2, 114688, v2
    global_load_lds_dwordx4 v2, s[24:25]
    s_add_u32 m0, s36, 82944
    v_subrev_u32 v3, 114688, v3
    global_load_lds_dwordx4 v3, s[26:27]
L_else_30:
    s_waitcnt lgkmcnt(0)
    s_barrier
    s_cmp_eq_u32 s43, 0
    s_cbranch_scc0 L_else_32
    s_mov_b32 exec_hi, 0
    s_waitcnt vmcnt(0)
L_chk_35:
    v_cmp_ne_u64 vcc, s[44:45], v[32:33]
    s_cbranch_vccnz L_again_37
L_ok_36:
    s_mov_b64 exec, -1
    v_mov_b32 v50, s44
    v_mov_b32 v51, s45
    s_mov_b64 exec, 0xffff
    global_load_dwordx4 v[48:51], v15, s[38:39] sc1
    s_mov_b64 exec, -1
    global_load_dwordx4 v[40:43], v14, s[38:39] sc1
    global_load_dwordx4 v[44:47], v31, s[38:39] sc1
    global_load_dwordx4 v[4:7], v12, s[38:39] sc1
    ds_read_b64 v[64:65], v24 offset:3776
    ds_read_b64 v[66:67], v24 offset:3784
    v_lshrrev_b32 v57, 4, v1
    v_and_b32 v56, 15, v1
    v_lshlrev_b32 v58, 5, v56
    ds_read_b64 v[68:69], v24 offset:3264
    ds_read_b64 v[70:71], v24 offset:3272
    v_lshl_add_u32 v58, v57, 4, v58
    s_lshr_b32 s48, s59, 1
    s_and_b32 s49, s59, 1
    ds_read_b64 v[72:73], v24 offset:2752
    ds_read_b64 v[74:75], v24 offset:2760
    s_lshl_b32 s49, s49, 8
    s_mul_i32 s50, s48, 4608
    s_sub_u32 s50, s50, s49
    ds_read_b64 v[76:77], v24 offset:2240
    ds_read_b64 v[78:79], v24 offset:2248
    s_add_u32 s50, s50, 131360
    v_add_u32 v25, s50, v58
    v_lshl_add_u32 v56, v57, 2, v56
    ds_read_b64 v[80:81], v24 offset:3712
    ds_read_b64 v[82:83], v24 offset:3720
    v_and_b32 v56, 15, v56
    v_lshl_add_u32 v56, v57, 4, v56
    s_lshl_b32 s50, s59, 12
    ds_read_b64 v[84:85], v24 offset:3200
    ds_read_b64 v[86:87], v24 offset:3208
    s_add_u32 s50, s50, 140288
    v_lshl_add_u32 v26, v56, 4, s50
    v_lshrrev_b32 v56, 2, v1
    ds_read_b64 v[88:89], v24 offset:2688
    ds_read_b64 v[90:91], v24 offset:2696
    v_and_b32 v57, 3, v1
    v_lshl_add_u32 v56, v57, 2, v56
    v_and_b32 v56, 15, v56
    ds_read_b64 v[92:93], v24 offset:2176
    ds_read_b64 v[94:95], v24 offset:2184
    v_lshl_add_u32 v56, v57, 4, v56
    s_lshl_b32 s50, s59, 10
    s_add_u32 s50, s50, 140288
    ds_read_b64 v[96:97], v24 offset:3648
    ds_read_b64 v[98:99], v24 offset:3656
    v_lshl_add_u32 v27, v56, 4, s50
    v_lshlrev_b32 v28, 3, v0
    v_add_u32 v28, 131584, v28
    ds_read_b64 v[100:101], v24 offset:3136
    ds_read_b64 v[102:103], v24 offset:3144
    v_lshrrev_b32 v56, 3, v0
    v_lshlrev_b32 v56, 15, v56
    v_and_b32 v57, 7, v1
    ds_read_b64 v[104:105], v24 offset:2624
    ds_read_b64 v[106:107], v24 offset:2632
    v_lshl_add_u32 v56, v57, 4, v56
    s_lshl_b32 s50, s40, 7
    s_add_u32 s50, s50, 5242880
    ds_read_b64 v[108:109], v24 offset:2112
    ds_read_b64 v[110:111], v24 offset:2120
    v_add_u32 v29, s50, v56
    v_add_u32 v30, 2097152, v29
    ds_read_b64 v[112:113], v24 offset:3584
    ds_read_b64 v[114:115], v24 offset:3592
    ds_read_b64 v[116:117], v24 offset:3072
    ds_read_b64 v[118:119], v24 offset:3080
    ds_read_b64 v[120:121], v24 offset:2560
    ds_read_b64 v[122:123], v24 offset:2568
    ds_read_b64 v[124:125], v24 offset:2048
    ds_read_b64 v[126:127], v24 offset:2056
    s_waitcnt vmcnt(1)
L_chk_40:
    v_cmp_ne_u64 vcc, s[44:45], v[42:43]
    v_cmp_ne_u64 s[48:49], s[44:45], v[46:47]
    v_cmp_ne_u64 s[50:51], s[44:45], v[50:51]
    s_nop 0
    s_or_b64 vcc, vcc, s[48:49]
    s_or_b64 vcc, vcc, s[50:51]
    s_cbranch_scc1 L_again_42
L_ok_41:
    s_mov_b64 exec, -1
    s_mov_b32 vcc_lo, 0x33333333
    s_mov_b32 vcc_hi, 0x33333333
    v_cndmask_b32_dpp v32, v44, v40, vcc quad_perm:[2,3,0,1] row_mask:0xf bank_mask:0xf bound_ctrl:0
    v_cndmask_b32_dpp v33, v45, v41, vcc quad_perm:[2,3,0,1] row_mask:0xf bank_mask:0xf bound_ctrl:0
    s_not_b64 vcc, vcc
    v_cndmask_b32_dpp v34, v40, v44, vcc quad_perm:[2,3,0,1] row_mask:0xf bank_mask:0xf bound_ctrl:0
    v_cndmask_b32_dpp v35, v41, v45, vcc quad_perm:[2,3,0,1] row_mask:0xf bank_mask:0xf bound_ctrl:0
    v_add_f32_dpp v48, v48, v48 quad_perm:[1,0,3,2] row_mask:0xf bank_mask:0xf
    v_add_f32_dpp v49, v49, v49 quad_perm:[1,0,3,2] row_mask:0xf bank_mask:0xf
    v_bfe_u32 v51, v1, 2, 1
    v_add_f32_dpp v48, v48, v48 quad_perm:[2,3,0,1] row_mask:0xf bank_mask:0xf
    v_add_f32_dpp v49, v49, v49 quad_perm:[2,3,0,1] row_mask:0xf bank_mask:0xf
    v_cvt_f32_u32 v51, v51
    v_cvt_pk_bf16_f32 v50, v48, v49
    v_lshlrev_b32 v48, 16, v50
    v_and_b32 v49, 0xffff0000, v50
    v_add_f32 v48, v48, v51
    v_add_f32 v49, v49, v51
    v_cvt_pk_bf16_f32 v50, v48, v49
    v_and_b32 v53, 0xffff0000, v32
    v_lshlrev_b32 v52, 16, v32
    v_rcp_f32 v53, v53
    v_readlane_b32 s7, v50, 0
    v_and_b32 v55, 0xffff0000, v33
    v_lshlrev_b32 v54, 16, v33
    v_rcp_f32 v55, v55
    v_readlane_b32 s9, v50, 4
    v_and_b32 v57, 0xffff0000, v34
    v_lshlrev_b32 v56, 16, v34
    v_rcp_f32 v57, v57
    v_and_b32 v59, 0xffff0000, v35
    v_lshlrev_b32 v58, 16, v35
    v_rcp_f32 v59, v59
    s_lshl_b32 s6, s7, 16
    s_and_b32 s7, s7, 0xffff0000
    s_lshl_b32 s8, s9, 16
    s_and_b32 s9, s9, 0xffff0000
    s_waitcnt vmcnt(0)
    v_lshlrev_b32 v248, 16, v4
    v_and_b32 v252, 0xffff0000, v4
    v_lshlrev_b32 v249, 16, v5
    v_and_b32 v253, 0xffff0000, v5
    v_lshlrev_b32 v250, 16, v6
    v_and_b32 v254, 0xffff0000, v6
    v_lshlrev_b32 v251, 16, v7
    v_and_b32 v255, 0xffff0000, v7
    v_sub_f32 v32, v248, v52
    v_mul_f32 v36, s8, v53
    v_sub_f32 v33, v249, v54
    v_mul_f32 v37, s8, v55
    v_sub_f32 v34, v250, v56
    v_mul_f32 v38, s8, v57
    v_sub_f32 v35, v251, v58
    v_mul_f32 v39, s8, v59
    v_fma_f32 v32, v32, v36, s6
    v_fma_f32 v33, v33, v37, s6
    v_fma_f32 v34, v34, v38, s6
    v_fma_f32 v35, v35, v39, s6
    v_cvt_pk_bf16_f32 v8, v32, v33
    v_cvt_pk_bf16_f32 v9, v34, v35
    ds_write_b64 v28, v[8:9] offset:0
    v_sub_f32 v32, v252, v52
    v_mul_f32 v36, s9, v53
    v_sub_f32 v33, v253, v54
    v_mul_f32 v37, s9, v55
    v_sub_f32 v34, v254, v56
    v_mul_f32 v38, s9, v57
    v_sub_f32 v35, v255, v58
    v_mul_f32 v39, s9, v59
    v_fma_f32 v32, v32, v36, s7
    v_fma_f32 v33, v33, v37, s7
    v_fma_f32 v34, v34, v38, s7
    v_fma_f32 v35, v35, v39, s7
    v_cvt_pk_bf16_f32 v10, v32, v33
    v_cvt_pk_bf16_f32 v11, v34, v35
    ds_write_b64 v28, v[10:11] offset:4608
    s_cmp_eq_u32 s3, 0
    s_cbranch_scc0 L_else_43
    s_mov_b32 m0, 163072
    s_nop 0
    ds_write_addtid_b32 v50 offset:0
L_else_43:
    v_mov_b32 v62, 161792
    v_mov_b32 v63, 1
    s_mov_b64 exec, 1
    ds_add_u32 v62, v63 offset:0
    s_mov_b64 exec, -1
    v_readlane_b32 s11, v50, 8
    v_readlane_b32 s13, v50, 12
    s_setprio 2
    v_mov_b32 v62, 161792
L_cw_45:
    ds_read_b32 v60, v62 offset:0
    s_waitcnt lgkmcnt(0)
    v_cmp_gt_u32 vcc, 4, v60
    s_cbranch_vccnz L_cw_45
    ds_read_b128 v[32:35], v25 offset:192
    ds_read_b128 v[36:39], v25 offset:704
    ds_read_b128 v[40:43], v25 offset:1216
    ds_read_b128 v[44:47], v25 offset:1728
    ds_read_b128 v[48:51], v25 offset:128
    ds_read_b128 v[52:55], v25 offset:640
    ds_read_b128 v[56:59], v25 offset:1152
    ds_read_b128 v[60:63], v25 offset:1664
    s_mov_b32 s15, s47
    s_lshl_b32 s14, s15, 16
    s_and_b32 s15, s15, 0xffff0000
    s_lshl_b32 s10, s11, 16
    s_and_b32 s11, s11, 0xffff0000
    s_lshl_b32 s12, s13, 16
    s_and_b32 s13, s13, 0xffff0000
    v_mov_b32 v12, s14
    v_mul_f32 v12, s10, v12
    v_lshlrev_b32 v13, 16, v8
    v_and_b32 v14, 0xffff0000, v8
    v_fmac_f32 v248, v12, v13
    s_waitcnt lgkmcnt(7)
    v_mfma_f32_16x16x32_bf16 v[16:19], v[64:67], v[32:35], 0
    v_fmac_f32 v249, v12, v14
    v_mfma_f32_16x16x32_bf16 v[20:23], v[68:71], v[32:35], 0
    v_lshlrev_b32 v13, 16, v9
    s_waitcnt lgkmcnt(6)
    v_mfma_f32_16x16x32_bf16 v[20:23], v[64:67], v[36:39], v[20:23]
    v_and_b32 v14, 0xffff0000, v9
    v_mfma_f32_16x16x32_bf16 v[128:131], v[72:75], v[32:35], 0
    v_fmac_f32 v250, v12, v13
    v_mfma_f32_16x16x32_bf16 v[128:131], v[68:71], v[36:39], v[128:131]
    v_fmac_f32 v251, v12, v14
    s_waitcnt lgkmcnt(5)
    v_mfma_f32_16x16x32_bf16 v[128:131], v[64:67], v[40:43], v[128:131]
    v_mov_b32 v12, s15
    v_mfma_f32_16x16x32_bf16 v[132:135], v[76:79], v[32:35], 0
    v_mul_f32 v12, s11, v12
    v_mfma_f32_16x16x32_bf16 v[132:135], v[72:75], v[36:39], v[132:135]
    v_lshlrev_b32 v13, 16, v10
    v_mfma_f32_16x16x32_bf16 v[132:135], v[68:71], v[40:43], v[132:135]
    v_and_b32 v14, 0xffff0000, v10
    s_waitcnt lgkmcnt(4)
    v_mfma_f32_16x16x32_bf16 v[132:135], v[64:67], v[44:47], v[132:135]
    v_fmac_f32 v252, v12, v13
    ds_read_b128 v[32:35], v25 offset:64
    ds_read_b128 v[36:39], v25 offset:576
    ds_read_b128 v[40:43], v25 offset:1088
    ds_read_b128 v[44:47], v25 offset:1600
    s_waitcnt lgkmcnt(7)
    v_mfma_f32_16x16x32_bf16 v[16:19], v[80:83], v[48:51], v[16:19]
    v_fmac_f32 v253, v12, v14
    v_mfma_f32_16x16x32_bf16 v[20:23], v[84:87], v[48:51], v[20:23]
    v_lshlrev_b32 v13, 16, v11
    s_waitcnt lgkmcnt(6)
    v_mfma_f32_16x16x32_bf16 v[20:23], v[80:83], v[52:55], v[20:23]
    v_and_b32 v14, 0xffff0000, v11
    v_mfma_f32_16x16x32_bf16 v[128:131], v[88:91], v[48:51], v[128:131]
    v_fmac_f32 v254, v12, v13
    v_mfma_f32_16x16x32_bf16 v[128:131], v[84:87], v[52:55], v[128:131]
    v_fmac_f32 v255, v12, v14
    s_waitcnt lgkmcnt(5)
    v_mfma_f32_16x16x32_bf16 v[128:131], v[80:83], v[56:59], v[128:131]
    v_mfma_f32_16x16x32_bf16 v[132:135], v[92:95], v[48:51], v[132:135]
    v_mfma_f32_16x16x32_bf16 v[132:135], v[88:91], v[52:55], v[132:135]
    v_mfma_f32_16x16x32_bf16 v[132:135], v[84:87], v[56:59], v[132:135]
    s_waitcnt lgkmcnt(4)
    v_mfma_f32_16x16x32_bf16 v[132:135], v[80:83], v[60:63], v[132:135]
    ds_read_b128 v[48:51], v25 offset:0
    ds_read_b128 v[52:55], v25 offset:512
    ds_read_b128 v[56:59], v25 offset:1024
    ds_read_b128 v[60:63], v25 offset:1536
    s_waitcnt lgkmcnt(7)
    v_mfma_f32_16x16x32_bf16 v[16:19], v[96:99], v[32:35], v[16:19]
    v_mfma_f32_16x16x32_bf16 v[20:23], v[100:103], v[32:35], v[20:23]
    s_waitcnt lgkmcnt(6)
    v_mfma_f32_16x16x32_bf16 v[20:23], v[96:99], v[36:39], v[20:23]
    v_mfma_f32_16x16x32_bf16 v[128:131], v[104:107], v[32:35], v[128:131]
    v_mfma_f32_16x16x32_bf16 v[128:131], v[100:103], v[36:39], v[128:131]
    s_waitcnt lgkmcnt(5)
    v_mfma_f32_16x16x32_bf16 v[128:131], v[96:99], v[40:43], v[128:131]
    v_mfma_f32_16x16x32_bf16 v[132:135], v[108:111], v[32:35], v[132:135]
    v_mfma_f32_16x16x32_bf16 v[132:135], v[104:107], v[36:39], v[132:135]
    v_mfma_f32_16x16x32_bf16 v[132:135], v[100:103], v[40:43], v[132:135]
    s_waitcnt lgkmcnt(4)
    v_mfma_f32_16x16x32_bf16 v[132:135], v[96:99], v[44:47], v[132:135]
    s_waitcnt lgkmcnt(3)
    v_mfma_f32_16x16x32_bf16 v[16:19], v[112:115], v[48:51], v[16:19]
    v_mfma_f32_16x16x32_bf16 v[20:23], v[116:119], v[48:51], v[20:23]
    s_waitcnt lgkmcnt(2)
    v_mfma_f32_16x16x32_bf16 v[20:23], v[112:115], v[52:55], v[20:23]
    v_mfma_f32_16x16x32_bf16 v[128:131], v[120:123], v[48:51], v[128:131]
    v_mfma_f32_16x16x32_bf16 v[128:131], v[116:119], v[52:55], v[128:131]
    s_waitcnt lgkmcnt(1)
    v_mfma_f32_16x16x32_bf16 v[128:131], v[112:115], v[56:59], v[128:131]
    s_nop 0
    ds_write_b128 v26, v[16:19] offset:0
    v_mfma_f32_16x16x32_bf16 v[132:135], v[124:127], v[48:51], v[132:135]
    v_mfma_f32_16x16x32_bf16 v[132:135], v[120:123], v[52:55], v[132:135]
    v_mfma_f32_16x16x32_bf16 v[132:135], v[116:119], v[56:59], v[132:135]
    s_waitcnt lgkmcnt(1)
    v_mfma_f32_16x16x32_bf16 v[132:135], v[112:115], v[60:63], v[132:135]
    ds_write_b128 v26, v[20:23] offset:1024
    ds_write_b128 v26, v[128:131] offset:2048
    s_nop 5
    ds_write_b128 v26, v[132:135] offset:3072
    v_mov_b32 v62, 161792
    v_mov_b32 v63, 1
    s_mov_b64 exec, 1
    ds_add_u32 v62, v63 offset:8
    s_mov_b64 exec, -1
    v_mov_b32 v62, 161792
L_cw_47:
    ds_read_b32 v60, v62 offset:8
    s_waitcnt lgkmcnt(0)
    v_cmp_gt_u32 vcc, 4, v60
    s_cbranch_vccnz L_cw_47
    ds_read_b128 v[64:67], v27 offset:0
    ds_read_b128 v[68:71], v27 offset:4096
    ds_read_b128 v[72:75], v27 offset:8192
    ds_read_b128 v[76:79], v27 offset:12288
    v_mov_b32 v62, 161792
    v_mov_b32 v63, 1
    s_mov_b64 exec, 1
    ds_add_u32 v62, v63 offset:12
    s_mov_b64 exec, -1
    s_waitcnt lgkmcnt(3)
    v_add_f32 v64, v64, v68
    v_add_f32 v65, v65, v69
    v_add_f32 v66, v66, v70
    v_add_f32 v67, v67, v71
    v_fmac_f32 v248, s10, v64
    v_fmac_f32 v249, s10, v65
    v_fmac_f32 v250, s10, v66
    v_fmac_f32 v251, s10, v67
    v_mul_f32 v64, s12, v248
    v_mul_f32 v65, s12, v249
    v_mul_f32 v66, s12, v250
    v_mul_f32 v67, s12, v251
    s_waitcnt lgkmcnt(1)
    v_add_f32 v72, v72, v76
    v_add_f32 v73, v73, v77
    v_add_f32 v74, v74, v78
    v_add_f32 v75, v75, v79
    v_fmac_f32 v252, s11, v72
    v_fmac_f32 v253, s11, v73
    v_fmac_f32 v254, s11, v74
    v_fmac_f32 v255, s11, v75
    v_mul_f32 v72, s13, v252
    v_mul_f32 v73, s13, v253
    v_mul_f32 v74, s13, v254
    v_mul_f32 v75, s13, v255
    v_cvt_pk_bf16_f32 v8, v64, v72
    v_cvt_pk_bf16_f32 v9, v65, v73
    v_cvt_pk_bf16_f32 v10, v66, v74
    v_cvt_pk_bf16_f32 v11, v67, v75
    global_store_dwordx4 v30, v[8:11], s[38:39] sc1
    v_cvt_pk_bf16_f32 v4, v248, v252
    v_cvt_pk_bf16_f32 v5, v249, v253
    v_cvt_pk_bf16_f32 v6, v250, v254
    v_cvt_pk_bf16_f32 v7, v251, v255
    global_store_dwordx4 v29, v[4:7], s[38:39] sc1
    s_lshl_b32 s48, s23, 5
    s_add_u32 s48, s48, s62
    s_lshl_b32 s48, s48, 7
    s_add_u32 s48, s48, 262144
    v_and_b32 v251, 3, v1
    v_lshl_add_u32 v251, v251, 7, s48
    s_mul_i32 s48, s23, 229376
    s_mul_i32 s49, s3, 28672
    s_add_u32 s48, s48, s49
    s_add_u32 s48, s48, 16781312
    v_lshl_add_u32 v248, v1, 4, s48
    s_lshr_b32 s48, s63, 3
    s_lshl_b32 s48, s48, 12
    s_lshl_b32 s49, s59, 10
    s_add_u32 s48, s48, s49
    s_add_u32 s48, s48, 294912
    v_lshl_add_u32 v70, v1, 4, s48
    s_lshl_b32 s48, s3, 12
    s_lshl_b32 s49, s40, 4
    s_add_u32 s48, s48, s49
    s_add_u32 s48, s48, 294912
    v_lshl_add_u32 v27, v1, 4, s48
    v_mov_b32 v32, s44
    v_mov_b32 v33, s45
    v_mov_b32 v34, s44
    v_mov_b32 v35, s45
    s_waitcnt vmcnt(0)
    s_mov_b64 exec, 1
    global_store_dwordx4 v27, v[32:35], s[38:39] sc1
    s_mov_b64 exec, -1
    s_cmp_lt_u32 s2, 224
    s_cbranch_scc0 L_else_49
    s_mov_b64 exec, 15
    v_mov_b32 v254, 0
    v_mov_b32 v255, 0
    global_atomic_add_x2 v[254:255], v251, v[254:255], s[38:39] sc0 sc1
    s_mov_b64 exec, -1
    s_branch L_end_50
L_else_49:
    v_lshrrev_b32 v30, 5, v0
    v_lshlrev_b32 v30, 11, v30
    v_and_b32 v31, 31, v1
    v_lshl_add_u32 v30, v31, 4, v30
    v_add_u32 v31, 196608, v30
    v_add_u32 v30, 180224, v30
    global_load_dwordx4 v[128:131], v30, s[38:39] offset:0 sc1
    global_load_dwordx4 v[132:135], v30, s[38:39] offset:512 sc1
    global_load_dwordx4 v[136:139], v30, s[38:39] offset:1024 sc1
    global_load_dwordx4 v[140:143], v30, s[38:39] offset:1536 sc1
    global_load_dwordx4 v[144:147], v31, s[38:39] offset:0 sc1
    global_load_dwordx4 v[148:151], v31, s[38:39] offset:512 sc1
    global_load_dwordx4 v[152:155], v31, s[38:39] offset:1024 sc1
    global_load_dwordx4 v[156:159], v31, s[38:39] offset:1536 sc1
L_end_50:
    v_mov_b32 v62, 161792
L_cw_51:
    ds_read_b32 v60, v62 offset:4
    s_waitcnt lgkmcnt(0)
    v_cmp_gt_u32 vcc, 4, v60
    s_cbranch_vccnz L_cw_51
    s_add_u32 m0, s36, 32768
    v_subrev_u32 v2, 1376256, v2
    global_load_lds_dwordx4 v2, s[24:25]
    s_add_u32 m0, s36, 33792
    v_subrev_u32 v3, 1376256, v3
    global_load_lds_dwordx4 v3, s[26:27]
    s_add_u32 m0, s36, 24576
    v_subrev_u32 v2, 114688, v2
    global_load_lds_dwordx4 v2, s[24:25]
    s_add_u32 m0, s36, 25600
    v_subrev_u32 v3, 114688, v3
    global_load_lds_dwordx4 v3, s[26:27]
    s_add_u32 m0, s36, 16384
    v_subrev_u32 v2, 114688, v2
    global_load_lds_dwordx4 v2, s[24:25]
    s_add_u32 m0, s36, 17408
    v_subrev_u32 v3, 114688, v3
    global_load_lds_dwordx4 v3, s[26:27]
    s_add_u32 m0, s36, 8192
    v_subrev_u32 v2, 114688, v2
    global_load_lds_dwordx4 v2, s[24:25]
    s_add_u32 m0, s36, 9216
    v_subrev_u32 v3, 114688, v3
    global_load_lds_dwordx4 v3, s[26:27]
    s_add_u32 m0, s36, 0
    v_subrev_u32 v2, 114688, v2
    global_load_lds_dwordx4 v2, s[24:25]
    s_add_u32 m0, s36, 1024
    v_subrev_u32 v3, 114688, v3
    global_load_lds_dwordx4 v3, s[26:27]
    s_cmp_lt_u32 s2, 224
    s_cbranch_scc0 L_else_52
    s_waitcnt vmcnt(10)
    s_mov_b64 exec, 15
L_chk_54:
    v_cmp_ne_u64 vcc, s[44:45], v[254:255]
    s_cbranch_vccnz L_again_56
L_ok_55:
    s_mov_b64 exec, -1
    global_load_dwordx4 v[136:139], v248, s[38:39] offset:-4096 sc1
    global_load_dwordx4 v[140:143], v248, s[38:39] offset:-3072 sc1
    global_load_dwordx4 v[144:147], v248, s[38:39] offset:-2048 sc1
    global_load_dwordx4 v[148:151], v248, s[38:39] offset:-1024 sc1
    global_load_dwordx4 v[152:155], v248, s[38:39] offset:0 sc1
    global_load_dwordx4 v[156:159], v248, s[38:39] offset:1024 sc1
    global_load_dwordx4 v[160:163], v248, s[38:39] offset:2048 sc1
    global_load_dwordx4 v[164:167], v248, s[38:39] offset:3072 sc1
    v_add_u32 v248, 8192, v248
    global_load_dwordx4 v[168:171], v248, s[38:39] offset:-4096 sc1
    global_load_dwordx4 v[172:175], v248, s[38:39] offset:-3072 sc1
    global_load_dwordx4 v[176:179], v248, s[38:39] offset:-2048 sc1
    global_load_dwordx4 v[180:183], v248, s[38:39] offset:-1024 sc1
    global_load_dwordx4 v[184:187], v248, s[38:39] offset:0 sc1
    global_load_dwordx4 v[188:191], v248, s[38:39] offset:1024 sc1
    v_lshrrev_b32 v8, 5, v1
    v_bfe_u32 v9, v1, 4, 1
    v_bfe_u32 v10, v1, 2, 2
    v_xor_b32 v11, v8, v9
    v_lshrrev_b32 v2, 1, v10
    v_lshl_add_u32 v11, v11, 1, v2
    v_lshlrev_b32 v2, 11, v8
    v_lshl_add_u32 v2, v9, 10, v2
    v_lshl_add_u32 v2, v10, 7, v2
    v_lshl_add_u32 v2, v11, 5, v2
    v_and_b32 v9, 1, v1
    v_bfe_u32 v10, v1, 1, 1
    v_lshl_or_b32 v7, v9, 1, v10
    v_lshl_add_u32 v2, v7, 3, v2
    v_xor_b32 v3, 32, v2
    v_xor_b32 v4, 64, v2
    v_xor_b32 v5, 0x60, v2
    v_and_b32 v9, 31, v1
    v_lshlrev_b32 v9, 2, v9
    v_lshl_add_u32 v9, v8, 9, v9
    s_lshl_b32 s48, s63, 15
    s_add_u32 s49, s48, 7344128
    v_add_u32 v6, s49, v9
    s_waitcnt vmcnt(14)
    global_load_dwordx2 v[60:61], v70, s[38:39] sc1
    s_waitcnt vmcnt(0)
L_chk_57:
    v_cmp_ne_u64 vcc, s[44:45], v[60:61]
    s_cbranch_vccnz L_again_59
L_ok_58:
    s_mov_b64 exec, -1
    v_mov_b32 v62, 161792
    v_mov_b32 v63, 1
    s_mov_b64 exec, 1
    ds_add_u32 v62, v63 offset:20
    s_mov_b64 exec, -1
    v_mov_b32 v62, 161792
L_cw_60:
    ds_read2_b32 v[60:61], v62 offset0:5 offset1:4
    s_waitcnt lgkmcnt(0)
    v_min_u32 v60, v60, v61
    v_cmp_gt_u32 vcc, 4, v60
    s_cbranch_vccnz L_cw_60
    s_branch L_end_53
L_else_52:
    s_waitcnt vmcnt(10)
L_chk_61:
    v_cmp_ne_u64 vcc, s[44:45], v[130:131]
    v_cmp_ne_u64 s[48:49], s[44:45], v[134:135]
    v_cmp_ne_u64 s[50:51], s[44:45], v[138:139]
    v_cmp_ne_u64 s[52:53], s[44:45], v[142:143]
    v_cmp_ne_u64 s[54:55], s[44:45], v[146:147]
    s_or_b64 vcc, vcc, s[48:49]
    s_or_b64 vcc, vcc, s[50:51]
    s_or_b64 vcc, vcc, s[52:53]
    s_or_b64 vcc, vcc, s[54:55]
    v_cmp_ne_u64 s[48:49], s[44:45], v[150:151]
    v_cmp_ne_u64 s[50:51], s[44:45], v[154:155]
    v_cmp_ne_u64 s[52:53], s[44:45], v[158:159]
    s_or_b64 vcc, vcc, s[48:49]
    s_or_b64 vcc, vcc, s[50:51]
    s_or_b64 vcc, vcc, s[52:53]
    s_cbranch_scc1 L_again_63
L_ok_62:
    s_mov_b64 exec, -1
    v_add_f32 v128, v128, v132
    v_add_f32 v129, v129, v133
    v_add_f32 v136, v136, v140
    v_add_f32 v137, v137, v141
    v_add_f32 v128, v128, v136
    v_add_f32 v129, v129, v137
    v_cvt_pk_bf16_f32 v128, v128, v129
    v_add_f32 v144, v144, v148
    v_add_f32 v145, v145, v149
    v_add_f32 v152, v152, v156
    v_add_f32 v153, v153, v157
    v_add_f32 v144, v144, v152
    v_add_f32 v145, v145, v153
    v_cvt_pk_bf16_f32 v144, v144, v145
    v_lshlrev_b32 v146, 16, v144
    v_and_b32 v147, 0xffff0000, v144
    v_add_f32 v146, 1.0, v146
    v_add_f32 v147, 1.0, v147
    v_cvt_pk_bf16_f32 v144, v146, v147
    v_lshlrev_b32 v146, 2, v0
    v_add_u32 v146, 156672, v146
    ds_write_b32 v146, v144
    ds_write_b32 v146, v128 offset:1024
    v_lshrrev_b32 v16, 4, v1
    v_bfe_u32 v17, v1, 2, 2
    v_and_b32 v18, 1, v16
    v_lshrrev_b32 v19, 1, v17
    v_lshl_add_u32 v18, v18, 1, v19
    v_xor_b32 v18, s59, v18
    v_lshlrev_b32 v19, 11, v16
    v_lshl_add_u32 v19, v17, 7, v19
    v_lshl_add_u32 v19, v18, 5, v19
    v_and_b32 v18, 1, v1
    v_bfe_u32 v17, v1, 1, 1
    v_lshl_or_b32 v17, v18, 1, v17
    v_lshl_add_u32 v12, v17, 3, v19
    v_xor_b32 v13, 64, v12
    v_add_u32 v13, 1024, v13
    v_lshlrev_b32 v18, 10, v18
    v_lshl_add_u32 v18, v16, 4, v18
    v_add_u32 v14, 156672, v18
    s_waitcnt vmcnt(0)
    v_mov_b32 v62, 161792
    v_mov_b32 v63, 1
    s_mov_b64 exec, 1
    ds_add_u32 v62, v63 offset:20
    s_mov_b64 exec, -1
    v_mov_b32 v62, 161792
L_cw_64:
    ds_read2_b32 v[60:61], v62 offset0:5 offset1:4
    s_waitcnt lgkmcnt(0)
    v_min_u32 v60, v60, v61
    v_cmp_gt_u32 vcc, 4, v60
    s_cbranch_vccnz L_cw_64
    ds_read_b128 v[72:75], v14 offset:0
    ds_read_b64_tr_b16 v[76:77], v12 offset:0
    ds_read_b64_tr_b16 v[78:79], v12 offset:512
    ds_read_b64_tr_b16 v[80:81], v13 offset:0
    ds_read_b64_tr_b16 v[82:83], v13 offset:512
    ds_read_b128 v[84:87], v14 offset:64
    ds_read_b64_tr_b16 v[88:89], v12 offset:8192
    ds_read_b64_tr_b16 v[90:91], v12 offset:8704
    ds_read_b64_tr_b16 v[92:93], v13 offset:8192
    ds_read_b64_tr_b16 v[94:95], v13 offset:8704
    ds_read_b128 v[96:99], v14 offset:128
    ds_read_b64_tr_b16 v[100:101], v12 offset:16384
    ds_read_b64_tr_b16 v[102:103], v12 offset:16896
    ds_read_b64_tr_b16 v[104:105], v13 offset:16384
    ds_read_b64_tr_b16 v[106:107], v13 offset:16896
    s_waitcnt lgkmcnt(10)
    ds_read_b128 v[108:111], v14 offset:192
    ds_read_b64_tr_b16 v[112:113], v12 offset:24576
    ds_read_b64_tr_b16 v[114:115], v12 offset:25088
    ds_read_b64_tr_b16 v[116:117], v13 offset:24576
    ds_read_b64_tr_b16 v[118:119], v13 offset:25088
    v_mfma_f32_16x16x32_bf16 v[16:19], v[72:75], v[76:79], 0
    v_mfma_f32_16x16x32_bf16 v[20:23], v[72:75], v[80:83], 0
    s_waitcnt lgkmcnt(10)
    ds_read_b128 v[72:75], v14 offset:256
    ds_read_b64_tr_b16 v[76:77], v12 offset:32768
    ds_read_b64_tr_b16 v[78:79], v12 offset:33280
    ds_read_b64_tr_b16 v[80:81], v13 offset:32768
    ds_read_b64_tr_b16 v[82:83], v13 offset:33280
    v_mfma_f32_16x16x32_bf16 v[16:19], v[84:87], v[88:91], v[16:19]
    v_mfma_f32_16x16x32_bf16 v[20:23], v[84:87], v[92:95], v[20:23]
    s_waitcnt lgkmcnt(10)
    ds_read_b128 v[84:87], v14 offset:320
    ds_read_b64_tr_b16 v[88:89], v12 offset:40960
    ds_read_b64_tr_b16 v[90:91], v12 offset:41472
    ds_read_b64_tr_b16 v[92:93], v13 offset:40960
    ds_read_b64_tr_b16 v[94:95], v13 offset:41472
    v_mfma_f32_16x16x32_bf16 v[16:19], v[96:99], v[100:103], v[16:19]
    v_mfma_f32_16x16x32_bf16 v[20:23], v[96:99], v[104:107], v[20:23]
    s_waitcnt lgkmcnt(10)
    ds_read_b128 v[96:99], v14 offset:384
    ds_read_b64_tr_b16 v[100:101], v12 offset:49152
    ds_read_b64_tr_b16 v[102:103], v12 offset:49664
    ds_read_b64_tr_b16 v[104:105], v13 offset:49152
    ds_read_b64_tr_b16 v[106:107], v13 offset:49664
    v_mfma_f32_16x16x32_bf16 v[16:19], v[108:111], v[112:115], v[16:19]
    v_mfma_f32_16x16x32_bf16 v[20:23], v[108:111], v[116:119], v[20:23]
    s_waitcnt lgkmcnt(10)
    ds_read_b128 v[108:111], v14 offset:448
    ds_read_b64_tr_b16 v[112:113], v12 offset:57344
    ds_read_b64_tr_b16 v[114:115], v12 offset:57856
    ds_read_b64_tr_b16 v[116:117], v13 offset:57344
    ds_read_b64_tr_b16 v[118:119], v13 offset:57856
    v_mfma_f32_16x16x32_bf16 v[16:19], v[72:75], v[76:79], v[16:19]
    v_mfma_f32_16x16x32_bf16 v[20:23], v[72:75], v[80:83], v[20:23]
    s_waitcnt lgkmcnt(10)
    v_add_u32 v12, 0x10000, v12
    v_add_u32 v13, 0x10000, v13
    ds_read_b128 v[72:75], v14 offset:512
    ds_read_b64_tr_b16 v[76:77], v12 offset:0
    ds_read_b64_tr_b16 v[78:79], v12 offset:512
    ds_read_b64_tr_b16 v[80:81], v13 offset:0
    ds_read_b64_tr_b16 v[82:83], v13 offset:512
    v_mfma_f32_16x16x32_bf16 v[16:19], v[84:87], v[88:91], v[16:19]
    v_mfma_f32_16x16x32_bf16 v[20:23], v[84:87], v[92:95], v[20:23]
    s_waitcnt lgkmcnt(10)
    ds_read_b128 v[84:87], v14 offset:576
    ds_read_b64_tr_b16 v[88:89], v12 offset:8192
    ds_read_b64_tr_b16 v[90:91], v12 offset:8704
    ds_read_b64_tr_b16 v[92:93], v13 offset:8192
    ds_read_b64_tr_b16 v[94:95], v13 offset:8704
    v_mfma_f32_16x16x32_bf16 v[16:19], v[96:99], v[100:103], v[16:19]
    v_mfma_f32_16x16x32_bf16 v[20:23], v[96:99], v[104:107], v[20:23]
    s_waitcnt lgkmcnt(10)
    ds_read_b128 v[96:99], v14 offset:640
    ds_read_b64_tr_b16 v[100:101], v12 offset:16384
    ds_read_b64_tr_b16 v[102:103], v12 offset:16896
    ds_read_b64_tr_b16 v[104:105], v13 offset:16384
    ds_read_b64_tr_b16 v[106:107], v13 offset:16896
    v_mfma_f32_16x16x32_bf16 v[16:19], v[108:111], v[112:115], v[16:19]
    v_mfma_f32_16x16x32_bf16 v[20:23], v[108:111], v[116:119], v[20:23]
    s_waitcnt lgkmcnt(10)
    ds_read_b128 v[108:111], v14 offset:704
    ds_read_b64_tr_b16 v[112:113], v12 offset:24576
    ds_read_b64_tr_b16 v[114:115], v12 offset:25088
    ds_read_b64_tr_b16 v[116:117], v13 offset:24576
    ds_read_b64_tr_b16 v[118:119], v13 offset:25088
    v_mfma_f32_16x16x32_bf16 v[16:19], v[72:75], v[76:79], v[16:19]
    v_mfma_f32_16x16x32_bf16 v[20:23], v[72:75], v[80:83], v[20:23]
    s_waitcnt lgkmcnt(10)
    ds_read_b128 v[72:75], v14 offset:768
    ds_read_b64_tr_b16 v[76:77], v12 offset:32768
    ds_read_b64_tr_b16 v[78:79], v12 offset:33280
    ds_read_b64_tr_b16 v[80:81], v13 offset:32768
    ds_read_b64_tr_b16 v[82:83], v13 offset:33280
    v_mfma_f32_16x16x32_bf16 v[16:19], v[84:87], v[88:91], v[16:19]
    v_mfma_f32_16x16x32_bf16 v[20:23], v[84:87], v[92:95], v[20:23]
    s_waitcnt lgkmcnt(10)
    ds_read_b128 v[84:87], v14 offset:832
    ds_read_b64_tr_b16 v[88:89], v12 offset:40960
    ds_read_b64_tr_b16 v[90:91], v12 offset:41472
    ds_read_b64_tr_b16 v[92:93], v13 offset:40960
    ds_read_b64_tr_b16 v[94:95], v13 offset:41472
    global_load_dwordx2 v[60:61], v70, s[38:39] sc1
    v_mfma_f32_16x16x32_bf16 v[16:19], v[96:99], v[100:103], v[16:19]
    v_mfma_f32_16x16x32_bf16 v[20:23], v[96:99], v[104:107], v[20:23]
    s_waitcnt lgkmcnt(10)
    ds_read_b128 v[96:99], v14 offset:896
    ds_read_b64_tr_b16 v[100:101], v12 offset:49152
    ds_read_b64_tr_b16 v[102:103], v12 offset:49664
    ds_read_b64_tr_b16 v[104:105], v13 offset:49152
    ds_read_b64_tr_b16 v[106:107], v13 offset:49664
    v_mfma_f32_16x16x32_bf16 v[16:19], v[108:111], v[112:115], v[16:19]
    v_mfma_f32_16x16x32_bf16 v[20:23], v[108:111], v[116:119], v[20:23]
    s_waitcnt lgkmcnt(10)
    ds_read_b128 v[108:111], v14 offset:960
    ds_read_b64_tr_b16 v[112:113], v12 offset:57344
    ds_read_b64_tr_b16 v[114:115], v12 offset:57856
    ds_read_b64_tr_b16 v[116:117], v13 offset:57344
    ds_read_b64_tr_b16 v[118:119], v13 offset:57856
    v_mfma_f32_16x16x32_bf16 v[16:19], v[72:75], v[76:79], v[16:19]
    v_mfma_f32_16x16x32_bf16 v[20:23], v[72:75], v[80:83], v[20:23]
    s_waitcnt lgkmcnt(10)
    v_mfma_f32_16x16x32_bf16 v[16:19], v[84:87], v[88:91], v[16:19]
    v_mfma_f32_16x16x32_bf16 v[20:23], v[84:87], v[92:95], v[20:23]
    s_waitcnt lgkmcnt(5)
    v_mfma_f32_16x16x32_bf16 v[16:19], v[96:99], v[100:103], v[16:19]
    v_mfma_f32_16x16x32_bf16 v[20:23], v[96:99], v[104:107], v[20:23]
    s_waitcnt lgkmcnt(0)
    v_mfma_f32_16x16x32_bf16 v[16:19], v[108:111], v[112:115], v[16:19]
    v_mfma_f32_16x16x32_bf16 v[20:23], v[108:111], v[116:119], v[20:23]
    s_mov_b32 vcc_lo, 0xffff0000
    s_mov_b32 vcc_hi, 0xffff0000
    s_lshl_b32 s48, s61, 11
    s_lshl_b32 s49, s59, 9
    s_add_u32 s48, s48, s49
    s_add_u32 s48, s48, 393216
    v_lshl_add_u32 v15, v1, 4, s48
    s_mov_b32 s48, 0x05040100
    s_mov_b32 s49, 0x07060302
    v_cndmask_b32 v16, v16, v20, vcc
    v_cndmask_b32 v17, v17, v21, vcc
    v_cvt_pk_bf16_f32 v24, v16, v17
    v_lshlrev_b32 v18, 16, v24
    v_and_b32 v19, 0xffff0000, v24
    v_sub_f32 v16, v16, v18
    v_sub_f32 v17, v17, v19
    v_cvt_pk_bf16_f32 v25, v16, v17
    v_mov_b32 v22, s44
    v_mov_b32 v23, s45
    v_perm_b32 v20, v25, v24, s48
    v_perm_b32 v21, v25, v24, s49
    s_mov_b32 exec_hi, 0
    global_store_dwordx4 v15, v[20:23], s[38:39] sc1
    s_mov_b32 exec_hi, -1
    s_waitcnt vmcnt(1)
L_chk_66:
    v_cmp_ne_u64 vcc, s[44:45], v[60:61]
    s_cbranch_vccnz L_again_68
L_ok_67:
    s_mov_b64 exec, -1
L_end_53:
    s_branch L_end_33
L_else_32:
    s_cmp_lt_u32 s2, 224
    s_cbranch_scc0 L_else_70
    s_mul_i32 s50, s41, 229376
    s_lshl_b32 s51, s42, 13
    s_add_u32 s50, s50, s51
    s_lshr_b32 s51, s59, 1
    s_mul_i32 s51, s51, 3072
    s_add_u32 s50, s50, s51
    s_lshl_b32 s51, s59, 9
    s_add_u32 s50, s50, s51
    s_add_u32 s50, s50, 16777216
    v_and_b32 v60, 15, v1
    v_lshl_add_u32 v60, v60, 4, s50
    v_bfe_u32 v61, v1, 4, 1
    v_lshl_add_u32 v60, v61, 11, v60
    v_lshrrev_b32 v61, 5, v1
    v_lshl_add_u32 v60, v61, 8, v60
    s_mov_b32 s50, 0x05040100
    s_mov_b32 s51, 0x07060302
    s_waitcnt vmcnt(13)
    v_perm_b32 v16, v113, v112, s50
    v_perm_b32 v17, v115, v114, s50
    v_perm_b32 v18, v117, v116, s50
    v_perm_b32 v19, v119, v118, s50
    global_store_dwordx4 v60, v[16:19], s[38:39] offset:0 sc1
    v_perm_b32 v20, v113, v112, s51
    v_perm_b32 v21, v115, v114, s51
    v_perm_b32 v22, v117, v116, s51
    v_perm_b32 v23, v119, v118, s51
    global_store_dwordx4 v60, v[20:23], s[38:39] offset:1024 sc1
L_else_70:
    ds_read_b64 v[128:129], v24 offset:3776
    ds_read_b64 v[130:131], v24 offset:3784
    v_lshrrev_b32 v57, 4, v1
    v_and_b32 v56, 15, v1
    v_lshlrev_b32 v58, 5, v56
    ds_read_b64 v[132:133], v24 offset:3264
    ds_read_b64 v[134:135], v24 offset:3272
    v_lshl_add_u32 v58, v57, 4, v58
    s_lshr_b32 s48, s59, 1
    s_and_b32 s49, s59, 1
    ds_read_b64 v[136:137], v24 offset:2752
    ds_read_b64 v[138:139], v24 offset:2760
    s_lshl_b32 s49, s49, 8
    s_mul_i32 s50, s48, 4608
    s_sub_u32 s50, s50, s49
    ds_read_b64 v[140:141], v24 offset:2240
    ds_read_b64 v[142:143], v24 offset:2248
    s_add_u32 s50, s50, 131360
    v_add_u32 v25, s50, v58
    v_lshl_add_u32 v56, v57, 2, v56
    ds_read_b64 v[144:145], v24 offset:1728
    ds_read_b64 v[146:147], v24 offset:1736
    v_and_b32 v56, 15, v56
    v_lshl_add_u32 v56, v57, 4, v56
    s_lshl_b32 s50, s59, 12
    ds_read_b64 v[148:149], v24 offset:1216
    ds_read_b64 v[150:151], v24 offset:1224
    s_add_u32 s50, s50, 140288
    v_lshl_add_u32 v26, v56, 4, s50
    v_lshrrev_b32 v56, 2, v1
    ds_read_b64 v[152:153], v24 offset:704
    ds_read_b64 v[154:155], v24 offset:712
    v_and_b32 v57, 3, v1
    v_lshl_add_u32 v56, v57, 2, v56
    v_and_b32 v56, 15, v56
    ds_read_b64 v[156:157], v24 offset:192
    ds_read_b64 v[158:159], v24 offset:200
    v_lshl_add_u32 v56, v57, 4, v56
    s_lshl_b32 s50, s59, 10
    s_add_u32 s50, s50, 140288
    ds_read_b64 v[160:161], v24 offset:3712
    ds_read_b64 v[162:163], v24 offset:3720
    v_lshl_add_u32 v27, v56, 4, s50
    v_lshlrev_b32 v28, 3, v0
    v_add_u32 v28, 131584, v28
    ds_read_b64 v[164:165], v24 offset:3200
    ds_read_b64 v[166:167], v24 offset:3208
    v_lshrrev_b32 v56, 3, v0
    v_lshlrev_b32 v56, 15, v56
    v_and_b32 v57, 7, v1
    ds_read_b64 v[168:169], v24 offset:2688
    ds_read_b64 v[170:171], v24 offset:2696
    v_lshl_add_u32 v56, v57, 4, v56
    s_lshl_b32 s50, s40, 7
    s_add_u32 s50, s50, 5242880
    ds_read_b64 v[172:173], v24 offset:2176
    ds_read_b64 v[174:175], v24 offset:2184
    v_add_u32 v29, s50, v56
    v_add_u32 v30, 2097152, v29
    ds_read_b64 v[176:177], v24 offset:1664
    ds_read_b64 v[178:179], v24 offset:1672
    ds_read_b64 v[180:181], v24 offset:1152
    ds_read_b64 v[182:183], v24 offset:1160
    ds_read_b64 v[184:185], v24 offset:640
    ds_read_b64 v[186:187], v24 offset:648
    ds_read_b64 v[188:189], v24 offset:128
    ds_read_b64 v[190:191], v24 offset:136
    ds_read_b64 v[192:193], v24 offset:3648
    ds_read_b64 v[194:195], v24 offset:3656
    ds_read_b64 v[196:197], v24 offset:3136
    ds_read_b64 v[198:199], v24 offset:3144
    ds_read_b64 v[200:201], v24 offset:2624
    ds_read_b64 v[202:203], v24 offset:2632
    ds_read_b64 v[204:205], v24 offset:2112
    ds_read_b64 v[206:207], v24 offset:2120
    ds_read_b64 v[208:209], v24 offset:1600
    ds_read_b64 v[210:211], v24 offset:1608
    ds_read_b64 v[212:213], v24 offset:1088
    ds_read_b64 v[214:215], v24 offset:1096
    ds_read_b64 v[216:217], v24 offset:576
    ds_read_b64 v[218:219], v24 offset:584
    ds_read_b64 v[220:221], v24 offset:64
    ds_read_b64 v[222:223], v24 offset:72
    ds_read_b64 v[224:225], v24 offset:3584
    ds_read_b64 v[226:227], v24 offset:3592
    ds_read_b64 v[228:229], v24 offset:3072
    ds_read_b64 v[230:231], v24 offset:3080
    ds_read_b64 v[232:233], v24 offset:2560
    ds_read_b64 v[234:235], v24 offset:2568
    ds_read_b64 v[236:237], v24 offset:2048
    ds_read_b64 v[238:239], v24 offset:2056
    ds_read_b64 v[240:241], v24 offset:1536
    ds_read_b64 v[242:243], v24 offset:1544
    ds_read_b64 v[244:245], v24 offset:1024
    ds_read_b64 v[246:247], v24 offset:1032
    ds_read_b64 v[248:249], v24 offset:512
    ds_read_b64 v[250:251], v24 offset:520
    ds_read_b64 v[252:253], v24 offset:0
    ds_read_b64 v[254:255], v24 offset:8
    s_mov_b32 exec_hi, 0
    s_waitcnt vmcnt(12)
L_chk_74:
    v_cmp_ne_u64 vcc, s[44:45], v[32:33]
    s_cbranch_vccnz L_again_76
L_ok_75:
    s_mov_b64 exec, -1
    global_load_dwordx4 v[40:43], v14, s[38:39] sc1
    global_load_dwordx4 v[44:47], v31, s[38:39] sc1
    global_load_dwordx4 v[4:7], v12, s[38:39] sc1
    s_cmp_lt_u32 s2, 224
    s_cbranch_scc0 L_else_77
    s_waitcnt vmcnt(3)
    v_mov_b32 v62, 161792
    v_mov_b32 v63, 1
    s_mov_b64 exec, 1
    ds_add_u32 v62, v63 offset:24
    s_mov_b64 exec, -1
    s_cmp_eq_u32 s3, 4
    s_cbranch_scc0 L_else_79
    s_lshl_b32 s48, s40, 7
    s_add_u32 s48, s48, 262144
    v_lshl_add_u32 v56, v1, 4, s48
    v_mov_b32 v52, s44
    v_mov_b32 v53, s45
    v_mov_b32 v54, s44
    v_mov_b32 v55, s45
    v_mov_b32 v62, 161792
L_cw_81:
    ds_read_b32 v60, v62 offset:24
    s_waitcnt lgkmcnt(0)
    v_cmp_gt_u32 vcc, 4, v60
    s_cbranch_vccnz L_cw_81
    s_mov_b64 exec, 255
    global_store_dwordx4 v56, v[52:55], s[38:39] sc1
    s_mov_b64 exec, -1
L_else_79:
L_else_77:
    s_add_u32 m0, s36, 73728
    v_subrev_u32 v2, 114688, v2
    global_load_lds_dwordx4 v2, s[24:25]
    s_add_u32 m0, s36, 74752
    v_subrev_u32 v3, 114688, v3
    global_load_lds_dwordx4 v3, s[26:27]
    s_add_u32 m0, s36, 65536
    v_subrev_u32 v2, 114688, v2
    global_load_lds_dwordx4 v2, s[24:25]
    s_add_u32 m0, s36, 66560
    v_subrev_u32 v3, 114688, v3
    global_load_lds_dwordx4 v3, s[26:27]
    s_add_u32 m0, s36, 57344
    v_subrev_u32 v2, 114688, v2
    global_load_lds_dwordx4 v2, s[24:25]
    s_add_u32 m0, s36, 58368
    v_subrev_u32 v3, 114688, v3
    global_load_lds_dwordx4 v3, s[26:27]
    s_add_u32 m0, s36, 49152
    v_subrev_u32 v2, 114688, v2
    global_load_lds_dwordx4 v2, s[24:25]
    s_add_u32 m0, s36, 50176
    v_subrev_u32 v3, 114688, v3
    global_load_lds_dwordx4 v3, s[26:27]
    s_add_u32 m0, s36, 40960
    v_subrev_u32 v2, 114688, v2
    global_load_lds_dwordx4 v2, s[24:25]
    s_add_u32 m0, s36, 41984
    v_subrev_u32 v3, 114688, v3
    global_load_lds_dwordx4 v3, s[26:27]
    s_waitcnt vmcnt(11)
L_chk_83:
    v_cmp_ne_u64 vcc, s[44:45], v[42:43]
    v_cmp_ne_u64 s[48:49], s[44:45], v[46:47]
    s_nop 1
    s_or_b64 vcc, vcc, s[48:49]
    s_cbranch_scc1 L_again_85
L_ok_84:
    s_mov_b64 exec, -1
    s_mov_b32 vcc_lo, 0x33333333
    s_mov_b32 vcc_hi, 0x33333333
    v_cndmask_b32_dpp v32, v44, v40, vcc quad_perm:[2,3,0,1] row_mask:0xf bank_mask:0xf bound_ctrl:0
    v_cndmask_b32_dpp v33, v45, v41, vcc quad_perm:[2,3,0,1] row_mask:0xf bank_mask:0xf bound_ctrl:0
    s_not_b64 vcc, vcc
    v_cndmask_b32_dpp v34, v40, v44, vcc quad_perm:[2,3,0,1] row_mask:0xf bank_mask:0xf bound_ctrl:0
    v_cndmask_b32_dpp v35, v41, v45, vcc quad_perm:[2,3,0,1] row_mask:0xf bank_mask:0xf bound_ctrl:0
    v_mov_b32 v62, 161792
L_cw_86:
    ds_read_b32 v60, v62 offset:0
    s_waitcnt lgkmcnt(0)
    v_cmp_gt_u32 vcc, 4, v60
    s_cbranch_vccz L_cok_87
    s_sleep 1
    s_branch L_cw_86
L_cok_87:
    s_mov_b32 m0, 163072
    s_nop 0
    ds_read_addtid_b32 v50 offset:0
    s_waitcnt lgkmcnt(0)
    v_and_b32 v53, 0xffff0000, v32
    v_lshlrev_b32 v52, 16, v32
    v_rcp_f32 v53, v53
    v_readlane_b32 s7, v50, 0
    v_and_b32 v55, 0xffff0000, v33
    v_lshlrev_b32 v54, 16, v33
    v_rcp_f32 v55, v55
    v_readlane_b32 s9, v50, 4
    v_and_b32 v57, 0xffff0000, v34
    v_lshlrev_b32 v56, 16, v34
    v_rcp_f32 v57, v57
    v_and_b32 v59, 0xffff0000, v35
    v_lshlrev_b32 v58, 16, v35
    v_rcp_f32 v59, v59
    s_lshl_b32 s6, s7, 16
    s_and_b32 s7, s7, 0xffff0000
    s_lshl_b32 s8, s9, 16
    s_and_b32 s9, s9, 0xffff0000
    s_waitcnt vmcnt(10)
    v_lshlrev_b32 v40, 16, v4
    v_and_b32 v44, 0xffff0000, v4
    v_lshlrev_b32 v41, 16, v5
    v_and_b32 v45, 0xffff0000, v5
    v_lshlrev_b32 v42, 16, v6
    v_and_b32 v46, 0xffff0000, v6
    v_lshlrev_b32 v43, 16, v7
    v_and_b32 v47, 0xffff0000, v7
    v_sub_f32 v32, v40, v52
    v_mul_f32 v36, s8, v53
    v_sub_f32 v33, v41, v54
    v_mul_f32 v37, s8, v55
    v_sub_f32 v34, v42, v56
    v_mul_f32 v38, s8, v57
    v_sub_f32 v35, v43, v58
    v_mul_f32 v39, s8, v59
    v_fma_f32 v32, v32, v36, s6
    v_fma_f32 v33, v33, v37, s6
    v_fma_f32 v34, v34, v38, s6
    v_fma_f32 v35, v35, v39, s6
    v_cvt_pk_bf16_f32 v8, v32, v33
    v_cvt_pk_bf16_f32 v9, v34, v35
    ds_write_b64 v28, v[8:9] offset:0
    v_sub_f32 v32, v44, v52
    v_mul_f32 v36, s9, v53
    v_sub_f32 v33, v45, v54
    v_mul_f32 v37, s9, v55
    v_sub_f32 v34, v46, v56
    v_mul_f32 v38, s9, v57
    v_sub_f32 v35, v47, v58
    v_mul_f32 v39, s9, v59
    v_fma_f32 v32, v32, v36, s7
    v_fma_f32 v33, v33, v37, s7
    v_fma_f32 v34, v34, v38, s7
    v_fma_f32 v35, v35, v39, s7
    v_cvt_pk_bf16_f32 v10, v32, v33
    v_cvt_pk_bf16_f32 v11, v34, v35
    ds_write_b64 v28, v[10:11] offset:4608
    v_mov_b32 v62, 161792
    v_mov_b32 v63, 1
    s_mov_b64 exec, 1
    ds_add_u32 v62, v63 offset:4
    s_mov_b64 exec, -1
    v_readlane_b32 s11, v50, 8
    v_readlane_b32 s13, v50, 12
    v_mov_b32 v62, 161792
L_cw_88:
    ds_read2_b32 v[60:61], v62 offset0:2 offset1:1
    s_waitcnt lgkmcnt(0)
    v_min_u32 v60, v60, v61
    v_cmp_gt_u32 vcc, 4, v60
    s_cbranch_vccnz L_cw_88
    ds_read_b128 v[64:67], v25 offset:192
    ds_read_b128 v[68:71], v25 offset:704
    ds_read_b128 v[72:75], v25 offset:1216
    ds_read_b128 v[76:79], v25 offset:1728
    ds_read_b128 v[80:83], v25 offset:2240
    ds_read_b128 v[84:87], v25 offset:2752
    ds_read_b128 v[88:91], v25 offset:3264
    ds_read_b128 v[92:95], v25 offset:3776
    ds_read_b128 v[96:99], v25 offset:128
    ds_read_b128 v[100:103], v25 offset:640
    ds_read_b128 v[104:107], v25 offset:1152
    ds_read_b128 v[108:111], v25 offset:1664
    ds_read_b128 v[112:115], v25 offset:2176
    ds_read_b128 v[116:119], v25 offset:2688
    ds_read_b128 v[120:123], v25 offset:3200
    ds_read_b128 v[124:127], v25 offset:3712
    s_mov_b32 s15, s47
    s_lshl_b32 s14, s15, 16
    s_and_b32 s15, s15, 0xffff0000
    s_lshl_b32 s10, s11, 16
    s_and_b32 s11, s11, 0xffff0000
    s_lshl_b32 s12, s13, 16
    s_and_b32 s13, s13, 0xffff0000
    v_mov_b32 v12, s14
    v_mul_f32 v12, s10, v12
    v_lshlrev_b32 v13, 16, v8
    v_and_b32 v14, 0xffff0000, v8
    v_fmac_f32 v40, v12, v13
    s_waitcnt lgkmcnt(15)
    v_mfma_f32_16x16x32_bf16 v[16:19], v[144:147], v[64:67], 0
    v_fmac_f32 v41, v12, v14
    s_waitcnt lgkmcnt(14)
    v_mfma_f32_16x16x32_bf16 v[16:19], v[140:143], v[68:71], v[16:19]
    v_lshlrev_b32 v13, 16, v9
    s_waitcnt lgkmcnt(13)
    v_mfma_f32_16x16x32_bf16 v[16:19], v[136:139], v[72:75], v[16:19]
    v_and_b32 v14, 0xffff0000, v9
    s_waitcnt lgkmcnt(12)
    v_mfma_f32_16x16x32_bf16 v[16:19], v[132:135], v[76:79], v[16:19]
    v_fmac_f32 v42, v12, v13
    s_waitcnt lgkmcnt(11)
    v_mfma_f32_16x16x32_bf16 v[16:19], v[128:131], v[80:83], v[16:19]
    v_fmac_f32 v43, v12, v14
    v_mfma_f32_16x16x32_bf16 v[20:23], v[148:151], v[64:67], 0
    v_mov_b32 v12, s15
    v_mfma_f32_16x16x32_bf16 v[20:23], v[144:147], v[68:71], v[20:23]
    v_mul_f32 v12, s11, v12
    v_mfma_f32_16x16x32_bf16 v[20:23], v[140:143], v[72:75], v[20:23]
    v_lshlrev_b32 v13, 16, v10
    v_mfma_f32_16x16x32_bf16 v[20:23], v[136:139], v[76:79], v[20:23]
    v_and_b32 v14, 0xffff0000, v10
    v_mfma_f32_16x16x32_bf16 v[20:23], v[132:135], v[80:83], v[20:23]
    v_fmac_f32 v44, v12, v13
    s_waitcnt lgkmcnt(10)
    v_mfma_f32_16x16x32_bf16 v[20:23], v[128:131], v[84:87], v[20:23]
    v_fmac_f32 v45, v12, v14
    v_mfma_f32_16x16x32_bf16 v[32:35], v[152:155], v[64:67], 0
    v_lshlrev_b32 v13, 16, v11
    v_mfma_f32_16x16x32_bf16 v[32:35], v[148:151], v[68:71], v[32:35]
    v_and_b32 v14, 0xffff0000, v11
    v_mfma_f32_16x16x32_bf16 v[32:35], v[144:147], v[72:75], v[32:35]
    v_fmac_f32 v46, v12, v13
    v_mfma_f32_16x16x32_bf16 v[32:35], v[140:143], v[76:79], v[32:35]
    v_fmac_f32 v47, v12, v14
    v_mfma_f32_16x16x32_bf16 v[32:35], v[136:139], v[80:83], v[32:35]
    v_mfma_f32_16x16x32_bf16 v[32:35], v[132:135], v[84:87], v[32:35]
    s_waitcnt lgkmcnt(9)
    v_mfma_f32_16x16x32_bf16 v[32:35], v[128:131], v[88:91], v[32:35]
    v_mfma_f32_16x16x32_bf16 v[36:39], v[156:159], v[64:67], 0
    v_mfma_f32_16x16x32_bf16 v[36:39], v[152:155], v[68:71], v[36:39]
    v_mfma_f32_16x16x32_bf16 v[36:39], v[148:151], v[72:75], v[36:39]
    v_mfma_f32_16x16x32_bf16 v[36:39], v[144:147], v[76:79], v[36:39]
    v_mfma_f32_16x16x32_bf16 v[36:39], v[140:143], v[80:83], v[36:39]
    v_mfma_f32_16x16x32_bf16 v[36:39], v[136:139], v[84:87], v[36:39]
    v_mfma_f32_16x16x32_bf16 v[36:39], v[132:135], v[88:91], v[36:39]
    s_waitcnt lgkmcnt(8)
    v_mfma_f32_16x16x32_bf16 v[36:39], v[128:131], v[92:95], v[36:39]
    ds_read_b128 v[64:67], v25 offset:64
    ds_read_b128 v[68:71], v25 offset:576
    ds_read_b128 v[72:75], v25 offset:1088
    ds_read_b128 v[76:79], v25 offset:1600
    ds_read_b128 v[80:83], v25 offset:2112
    ds_read_b128 v[84:87], v25 offset:2624
    ds_read_b128 v[88:91], v25 offset:3136
    ds_read_b128 v[92:95], v25 offset:3648
    s_waitcnt lgkmcnt(15)
    v_mfma_f32_16x16x32_bf16 v[16:19], v[176:179], v[96:99], v[16:19]
    s_waitcnt lgkmcnt(14)
    v_mfma_f32_16x16x32_bf16 v[16:19], v[172:175], v[100:103], v[16:19]
    s_waitcnt lgkmcnt(13)
    v_mfma_f32_16x16x32_bf16 v[16:19], v[168:171], v[104:107], v[16:19]
    s_waitcnt lgkmcnt(12)
    v_mfma_f32_16x16x32_bf16 v[16:19], v[164:167], v[108:111], v[16:19]
    s_waitcnt lgkmcnt(11)
    v_mfma_f32_16x16x32_bf16 v[16:19], v[160:163], v[112:115], v[16:19]
    v_mfma_f32_16x16x32_bf16 v[20:23], v[180:183], v[96:99], v[20:23]
    v_mfma_f32_16x16x32_bf16 v[20:23], v[176:179], v[100:103], v[20:23]
    v_mfma_f32_16x16x32_bf16 v[20:23], v[172:175], v[104:107], v[20:23]
    v_mfma_f32_16x16x32_bf16 v[20:23], v[168:171], v[108:111], v[20:23]
    v_mfma_f32_16x16x32_bf16 v[20:23], v[164:167], v[112:115], v[20:23]
    s_waitcnt lgkmcnt(10)
    v_mfma_f32_16x16x32_bf16 v[20:23], v[160:163], v[116:119], v[20:23]
    v_mfma_f32_16x16x32_bf16 v[32:35], v[184:187], v[96:99], v[32:35]
    v_mfma_f32_16x16x32_bf16 v[32:35], v[180:183], v[100:103], v[32:35]
    v_mfma_f32_16x16x32_bf16 v[32:35], v[176:179], v[104:107], v[32:35]
    v_mfma_f32_16x16x32_bf16 v[32:35], v[172:175], v[108:111], v[32:35]
    v_mfma_f32_16x16x32_bf16 v[32:35], v[168:171], v[112:115], v[32:35]
    v_mfma_f32_16x16x32_bf16 v[32:35], v[164:167], v[116:119], v[32:35]
    s_waitcnt lgkmcnt(9)
    v_mfma_f32_16x16x32_bf16 v[32:35], v[160:163], v[120:123], v[32:35]
    v_mfma_f32_16x16x32_bf16 v[36:39], v[188:191], v[96:99], v[36:39]
    v_mfma_f32_16x16x32_bf16 v[36:39], v[184:187], v[100:103], v[36:39]
    v_mfma_f32_16x16x32_bf16 v[36:39], v[180:183], v[104:107], v[36:39]
    v_mfma_f32_16x16x32_bf16 v[36:39], v[176:179], v[108:111], v[36:39]
    v_mfma_f32_16x16x32_bf16 v[36:39], v[172:175], v[112:115], v[36:39]
    v_mfma_f32_16x16x32_bf16 v[36:39], v[168:171], v[116:119], v[36:39]
    v_mfma_f32_16x16x32_bf16 v[36:39], v[164:167], v[120:123], v[36:39]
    s_waitcnt lgkmcnt(8)
    v_mfma_f32_16x16x32_bf16 v[36:39], v[160:163], v[124:127], v[36:39]
    ds_read_b128 v[96:99], v25 offset:0
    ds_read_b128 v[100:103], v25 offset:512
    ds_read_b128 v[104:107], v25 offset:1024
    ds_read_b128 v[108:111], v25 offset:1536
    ds_read_b128 v[112:115], v25 offset:2048
    ds_read_b128 v[116:119], v25 offset:2560
    ds_read_b128 v[120:123], v25 offset:3072
    ds_read_b128 v[124:127], v25 offset:3584
    s_waitcnt lgkmcnt(15)
    v_mfma_f32_16x16x32_bf16 v[16:19], v[208:211], v[64:67], v[16:19]
    s_waitcnt lgkmcnt(14)
    v_mfma_f32_16x16x32_bf16 v[16:19], v[204:207], v[68:71], v[16:19]
    s_waitcnt lgkmcnt(13)
    v_mfma_f32_16x16x32_bf16 v[16:19], v[200:203], v[72:75], v[16:19]
    s_waitcnt lgkmcnt(12)
    v_mfma_f32_16x16x32_bf16 v[16:19], v[196:199], v[76:79], v[16:19]
    s_waitcnt lgkmcnt(11)
    v_mfma_f32_16x16x32_bf16 v[16:19], v[192:195], v[80:83], v[16:19]
    v_mfma_f32_16x16x32_bf16 v[20:23], v[212:215], v[64:67], v[20:23]
    v_mfma_f32_16x16x32_bf16 v[20:23], v[208:211], v[68:71], v[20:23]
    v_mfma_f32_16x16x32_bf16 v[20:23], v[204:207], v[72:75], v[20:23]
    v_mfma_f32_16x16x32_bf16 v[20:23], v[200:203], v[76:79], v[20:23]
    v_mfma_f32_16x16x32_bf16 v[20:23], v[196:199], v[80:83], v[20:23]
    s_waitcnt lgkmcnt(10)
    v_mfma_f32_16x16x32_bf16 v[20:23], v[192:195], v[84:87], v[20:23]
    v_mfma_f32_16x16x32_bf16 v[32:35], v[216:219], v[64:67], v[32:35]
    v_mfma_f32_16x16x32_bf16 v[32:35], v[212:215], v[68:71], v[32:35]
    v_mfma_f32_16x16x32_bf16 v[32:35], v[208:211], v[72:75], v[32:35]
    v_mfma_f32_16x16x32_bf16 v[32:35], v[204:207], v[76:79], v[32:35]
    v_mfma_f32_16x16x32_bf16 v[32:35], v[200:203], v[80:83], v[32:35]
    v_mfma_f32_16x16x32_bf16 v[32:35], v[196:199], v[84:87], v[32:35]
    s_waitcnt lgkmcnt(9)
    v_mfma_f32_16x16x32_bf16 v[32:35], v[192:195], v[88:91], v[32:35]
    v_mfma_f32_16x16x32_bf16 v[36:39], v[220:223], v[64:67], v[36:39]
    v_mfma_f32_16x16x32_bf16 v[36:39], v[216:219], v[68:71], v[36:39]
    v_mfma_f32_16x16x32_bf16 v[36:39], v[212:215], v[72:75], v[36:39]
    v_mfma_f32_16x16x32_bf16 v[36:39], v[208:211], v[76:79], v[36:39]
    v_mfma_f32_16x16x32_bf16 v[36:39], v[204:207], v[80:83], v[36:39]
    v_mfma_f32_16x16x32_bf16 v[36:39], v[200:203], v[84:87], v[36:39]
    v_mfma_f32_16x16x32_bf16 v[36:39], v[196:199], v[88:91], v[36:39]
    s_waitcnt lgkmcnt(8)
    v_mfma_f32_16x16x32_bf16 v[36:39], v[192:195], v[92:95], v[36:39]
    v_mov_b32 v62, 161792
L_cw_90:
    ds_read_b32 v60, v62 offset:12
    s_waitcnt lgkmcnt(0)
    v_cmp_gt_u32 vcc, 4, v60
    s_cbranch_vccnz L_cw_90
    v_mfma_f32_16x16x32_bf16 v[16:19], v[240:243], v[96:99], v[16:19]
    v_mfma_f32_16x16x32_bf16 v[16:19], v[236:239], v[100:103], v[16:19]
    v_mfma_f32_16x16x32_bf16 v[16:19], v[232:235], v[104:107], v[16:19]
    v_mfma_f32_16x16x32_bf16 v[16:19], v[228:231], v[108:111], v[16:19]
    v_mfma_f32_16x16x32_bf16 v[16:19], v[224:227], v[112:115], v[16:19]
    v_mfma_f32_16x16x32_bf16 v[20:23], v[244:247], v[96:99], v[20:23]
    v_mfma_f32_16x16x32_bf16 v[20:23], v[240:243], v[100:103], v[20:23]
    v_mfma_f32_16x16x32_bf16 v[20:23], v[236:239], v[104:107], v[20:23]
    v_mfma_f32_16x16x32_bf16 v[20:23], v[232:235], v[108:111], v[20:23]
    v_mfma_f32_16x16x32_bf16 v[20:23], v[228:231], v[112:115], v[20:23]
    v_mfma_f32_16x16x32_bf16 v[20:23], v[224:227], v[116:119], v[20:23]
    v_mfma_f32_16x16x32_bf16 v[32:35], v[248:251], v[96:99], v[32:35]
    v_mfma_f32_16x16x32_bf16 v[32:35], v[244:247], v[100:103], v[32:35]
    v_mfma_f32_16x16x32_bf16 v[32:35], v[240:243], v[104:107], v[32:35]
    v_mfma_f32_16x16x32_bf16 v[32:35], v[236:239], v[108:111], v[32:35]
    v_mfma_f32_16x16x32_bf16 v[32:35], v[232:235], v[112:115], v[32:35]
    v_mfma_f32_16x16x32_bf16 v[32:35], v[228:231], v[116:119], v[32:35]
    v_mfma_f32_16x16x32_bf16 v[32:35], v[224:227], v[120:123], v[32:35]
    ds_write_b128 v26, v[16:19] offset:0
    v_mfma_f32_16x16x32_bf16 v[36:39], v[252:255], v[96:99], v[36:39]
    v_mfma_f32_16x16x32_bf16 v[36:39], v[248:251], v[100:103], v[36:39]
    v_mfma_f32_16x16x32_bf16 v[36:39], v[244:247], v[104:107], v[36:39]
    v_mfma_f32_16x16x32_bf16 v[36:39], v[240:243], v[108:111], v[36:39]
    v_mfma_f32_16x16x32_bf16 v[36:39], v[236:239], v[112:115], v[36:39]
    v_mfma_f32_16x16x32_bf16 v[36:39], v[232:235], v[116:119], v[36:39]
    v_mfma_f32_16x16x32_bf16 v[36:39], v[228:231], v[120:123], v[36:39]
    v_mfma_f32_16x16x32_bf16 v[36:39], v[224:227], v[124:127], v[36:39]
    ds_write_b128 v26, v[20:23] offset:1024
    ds_write_b128 v26, v[32:35] offset:2048
    s_nop 5
    ds_write_b128 v26, v[36:39] offset:3072
    s_waitcnt vmcnt(0)
    v_mov_b32 v62, 161792
    v_mov_b32 v63, 1
    s_mov_b64 exec, 1
    ds_add_u32 v62, v63 offset:16
    s_mov_b64 exec, -1
    v_mov_b32 v62, 161792
L_cw_91:
    ds_read_b32 v60, v62 offset:16
    s_waitcnt lgkmcnt(0)
    v_cmp_gt_u32 vcc, 4, v60
    s_cbranch_vccnz L_cw_91
    s_setprio 3
    ds_read_b128 v[64:67], v27 offset:0
    ds_read_b128 v[68:71], v27 offset:4096
    ds_read_b128 v[72:75], v27 offset:8192
    ds_read_b128 v[76:79], v27 offset:12288
    s_waitcnt lgkmcnt(2)
    v_add_f32 v64, v64, v68
    v_add_f32 v65, v65, v69
    v_add_f32 v66, v66, v70
    v_add_f32 v67, v67, v71
    v_fmac_f32 v40, s10, v64
    v_fmac_f32 v41, s10, v65
    v_fmac_f32 v42, s10, v66
    v_fmac_f32 v43, s10, v67
    v_mul_f32 v64, s12, v40
    v_mul_f32 v65, s12, v41
    v_mul_f32 v66, s12, v42
    v_mul_f32 v67, s12, v43
    s_waitcnt lgkmcnt(0)
    v_add_f32 v72, v72, v76
    v_add_f32 v73, v73, v77
    v_add_f32 v74, v74, v78
    v_add_f32 v75, v75, v79
    v_fmac_f32 v44, s11, v72
    v_fmac_f32 v45, s11, v73
    v_fmac_f32 v46, s11, v74
    v_fmac_f32 v47, s11, v75
    v_mul_f32 v72, s13, v44
    v_mul_f32 v73, s13, v45
    v_mul_f32 v74, s13, v46
    v_mul_f32 v75, s13, v47
    v_cvt_pk_bf16_f32 v8, v64, v72
    v_cvt_pk_bf16_f32 v9, v65, v73
    v_cvt_pk_bf16_f32 v10, v66, v74
    v_cvt_pk_bf16_f32 v11, v67, v75
    global_store_dwordx4 v30, v[8:11], s[38:39] sc1
    v_cvt_pk_bf16_f32 v4, v40, v44
    v_cvt_pk_bf16_f32 v5, v41, v45
    v_cvt_pk_bf16_f32 v6, v42, v46
    v_cvt_pk_bf16_f32 v7, v43, v47
    global_store_dwordx4 v29, v[4:7], s[38:39] sc1
    s_lshl_b32 s48, s23, 5
    s_add_u32 s48, s48, s62
    s_lshl_b32 s48, s48, 7
    s_add_u32 s48, s48, 262144
    v_and_b32 v251, 3, v1
    v_lshl_add_u32 v251, v251, 7, s48
    s_mul_i32 s48, s23, 229376
    s_mul_i32 s49, s3, 28672
    s_add_u32 s48, s48, s49
    s_add_u32 s48, s48, 16781312
    v_lshl_add_u32 v248, v1, 4, s48
    s_lshr_b32 s48, s63, 3
    s_lshl_b32 s48, s48, 12
    s_lshl_b32 s49, s59, 10
    s_add_u32 s48, s48, s49
    s_add_u32 s48, s48, 294912
    v_lshl_add_u32 v70, v1, 4, s48
    s_lshl_b32 s48, s3, 12
    s_lshl_b32 s49, s40, 4
    s_add_u32 s48, s48, s49
    s_add_u32 s48, s48, 294912
    v_lshl_add_u32 v27, v1, 4, s48
    v_mov_b32 v32, s44
    v_mov_b32 v33, s45
    v_mov_b32 v34, s44
    v_mov_b32 v35, s45
    s_waitcnt vmcnt(0)
    s_mov_b64 exec, 1
    global_store_dwordx4 v27, v[32:35], s[38:39] sc1
    s_mov_b64 exec, -1
    s_mov_b64 exec, 15
    v_mov_b32 v254, 0
    v_mov_b32 v255, 0
    global_atomic_add_x2 v[254:255], v251, v[254:255], s[38:39] sc0 sc1
    s_mov_b64 exec, -1
    s_cmp_eq_u32 s3, 4
    s_cbranch_scc0 L_else_93
    s_add_u32 s48, s23, 40
    s_lshl_b32 s48, s48, 11
    s_add_u32 s48, s48, 131072
    v_and_b32 v25, 31, v1
    v_lshl_add_u32 v24, v25, 4, s48
    s_mov_b32 exec_hi, 0
    global_load_dwordx4 v[8:11], v24, s[38:39] offset:0 sc1
    global_load_dwordx4 v[12:15], v24, s[38:39] offset:512 sc1
    global_load_dwordx4 v[16:19], v24, s[38:39] offset:1024 sc1
    global_load_dwordx4 v[20:23], v24, s[38:39] offset:1536 sc1
    s_waitcnt vmcnt(0)
L_chk_95:
    v_cmp_ne_u64 vcc, s[44:45], v[10:11]
    v_cmp_ne_u64 s[48:49], s[44:45], v[14:15]
    v_cmp_ne_u64 s[50:51], s[44:45], v[18:19]
    v_cmp_ne_u64 s[52:53], s[44:45], v[22:23]
    s_or_b64 vcc, vcc, s[48:49]
    s_or_b64 vcc, vcc, s[50:51]
    s_or_b64 vcc, vcc, s[52:53]
    s_cbranch_scc1 L_again_97
L_ok_96:
    s_mov_b64 exec, -1
    v_add_f32 v8, v8, v12
    v_add_f32 v9, v9, v13
    v_add_f32 v16, v16, v20
    v_add_f32 v17, v17, v21
    v_add_f32 v8, v8, v16
    v_add_f32 v9, v9, v17
    v_cvt_pk_bf16_f32 v10, v8, v9
    v_lshlrev_b32 v8, 16, v10
    v_and_b32 v9, 0xffff0000, v10
    v_lshlrev_b32 v25, 3, v25
    v_add_u32 v25, 163584, v25
    s_mov_b32 exec_hi, 0
    ds_write_b64 v25, v[8:9]
    s_mov_b32 exec_hi, -1
L_else_93:
    s_waitcnt vmcnt(0)
    s_mov_b64 exec, 15
L_chk_98:
    v_cmp_ne_u64 vcc, s[44:45], v[254:255]
    s_cbranch_vccnz L_again_100
L_ok_99:
    s_mov_b64 exec, -1
    s_cmp_lt_u32 s2, 224
    s_cbranch_scc0 L_else_101
    v_lshrrev_b32 v8, 5, v1
    v_bfe_u32 v9, v1, 4, 1
    v_bfe_u32 v10, v1, 2, 2
    v_xor_b32 v11, v8, v9
    v_lshrrev_b32 v2, 1, v10
    v_lshl_add_u32 v11, v11, 1, v2
    v_lshlrev_b32 v2, 11, v8
    v_lshl_add_u32 v2, v9, 10, v2
    v_lshl_add_u32 v2, v10, 7, v2
    v_lshl_add_u32 v2, v11, 5, v2
    v_and_b32 v9, 1, v1
    v_bfe_u32 v10, v1, 1, 1
    v_lshl_or_b32 v7, v9, 1, v10
    v_lshl_add_u32 v2, v7, 3, v2
    v_xor_b32 v3, 32, v2
    v_xor_b32 v4, 64, v2
    v_xor_b32 v5, 0x60, v2
    v_and_b32 v9, 31, v1
    v_lshlrev_b32 v9, 2, v9
    v_lshl_add_u32 v9, v8, 9, v9
    s_lshl_b32 s48, s63, 15
    s_add_u32 s49, s48, 7344128
    v_add_u32 v6, s49, v9
L_else_101:
    global_load_dwordx4 v[136:139], v248, s[38:39] offset:-4096 sc1
    global_load_dwordx4 v[140:143], v248, s[38:39] offset:-3072 sc1
    global_load_dwordx4 v[144:147], v248, s[38:39] offset:-2048 sc1
    global_load_dwordx4 v[148:151], v248, s[38:39] offset:-1024 sc1
    s_waitcnt vmcnt(3)
    global_load_dwordx4 v[152:155], v248, s[38:39] offset:0 sc1
    s_waitcnt vmcnt(3)
    global_load_dwordx4 v[156:159], v248, s[38:39] offset:1024 sc1
    s_waitcnt vmcnt(3)
    global_load_dwordx4 v[160:163], v248, s[38:39] offset:2048 sc1
    s_waitcnt vmcnt(3)
    global_load_dwordx4 v[164:167], v248, s[38:39] offset:3072 sc1
    s_waitcnt vmcnt(3)
    v_add_u32 v248, 8192, v248
    global_load_dwordx4 v[168:171], v248, s[38:39] offset:-4096 sc1
    s_waitcnt vmcnt(3)
    global_load_dwordx4 v[172:175], v248, s[38:39] offset:-3072 sc1
    s_waitcnt vmcnt(3)
    global_load_dwordx4 v[176:179], v248, s[38:39] offset:-2048 sc1
    s_waitcnt vmcnt(3)
    global_load_dwordx4 v[180:183], v248, s[38:39] offset:-1024 sc1
    s_waitcnt vmcnt(3)
    global_load_dwordx4 v[184:187], v248, s[38:39] offset:0 sc1
    s_waitcnt vmcnt(3)
    global_load_dwordx4 v[188:191], v248, s[38:39] offset:1024 sc1
    global_load_dwordx2 v[60:61], v70, s[38:39] sc1
    s_waitcnt vmcnt(4)
    global_load_dwordx4 v[192:195], v248, s[38:39] offset:2048 sc1
    s_waitcnt vmcnt(4)
    global_load_dwordx4 v[196:199], v248, s[38:39] offset:3072 sc1
    s_waitcnt vmcnt(4)
    v_add_u32 v248, 8192, v248
    global_load_dwordx4 v[200:203], v248, s[38:39] offset:-4096 sc1
    s_waitcnt vmcnt(4)
    global_load_dwordx4 v[204:207], v248, s[38:39] offset:-3072 sc1
    s_waitcnt vmcnt(4)
L_chk_103:
    v_cmp_ne_u64 vcc, s[44:45], v[60:61]
    s_cbranch_vccnz L_again_105
L_ok_104:
    s_mov_b64 exec, -1
    v_mov_b32 v62, 161792
    v_mov_b32 v63, 1
    s_mov_b64 exec, 1
    ds_add_u32 v62, v63 offset:36
    s_mov_b64 exec, -1
    s_cmp_lt_u32 s2, 224
    s_cbranch_scc0 L_else_106
    s_waitcnt vmcnt(3)
    global_load_dwordx4 v[208:211], v248, s[38:39] offset:-2048 sc1
    s_waitcnt vmcnt(3)
    global_load_dwordx4 v[212:215], v248, s[38:39] offset:-1024 sc1
    s_waitcnt vmcnt(3)
    global_load_dwordx4 v[216:219], v248, s[38:39] offset:0 sc1
    s_waitcnt vmcnt(3)
    global_load_dwordx4 v[220:223], v248, s[38:39] offset:1024 sc1
    s_waitcnt vmcnt(3)
    global_load_dwordx4 v[224:227], v248, s[38:39] offset:2048 sc1
    s_waitcnt vmcnt(3)
    global_load_dwordx4 v[228:231], v248, s[38:39] offset:3072 sc1
    s_xor_b32 s48, s63, 32
    s_lshl_b32 s48, s48, 9
    s_add_u32 s48, s48, 524288
    v_lshl_add_u32 v48, v1, 4, s48
    s_lshl_b32 s48, s61, 11
    s_lshl_b32 s49, s59, 9
    s_add_u32 s48, s48, s49
    s_add_u32 s48, s48, 393216
    v_lshl_add_u32 v49, v1, 4, s48
    s_mov_b32 exec_hi, 0
    global_load_dwordx4 v[40:43], v48, s[38:39] sc1
    global_load_dwordx4 v[44:47], v49, s[38:39] sc1
    s_mov_b32 exec_hi, -1
    s_waitcnt vmcnt(5)
    v_add_u32 v248, 8192, v248
    global_load_dwordx4 v[232:235], v248, s[38:39] offset:-4096 sc1
    s_waitcnt vmcnt(5)
    global_load_dwordx4 v[236:239], v248, s[38:39] offset:-3072 sc1
    s_waitcnt vmcnt(5)
    global_load_dwordx4 v[240:243], v248, s[38:39] offset:-2048 sc1
    s_waitcnt vmcnt(5)
    global_load_dwordx4 v[244:247], v248, s[38:39] offset:-1024 sc1
    s_mov_b32 exec_hi, 0
    s_waitcnt vmcnt(4)
L_chk_108:
    v_cmp_ne_u64 vcc, s[44:45], v[42:43]
    v_cmp_ne_u64 s[48:49], s[44:45], v[46:47]
    s_nop 1
    s_or_b64 vcc, vcc, s[48:49]
    s_cbranch_scc1 L_again_110
L_ok_109:
    s_mov_b64 exec, -1
    s_lshl_b32 s48, s59, 8
    s_add_u32 s49, s48, 158720
    v_lshl_add_u32 v48, v1, 3, s49
    s_mov_b32 exec_hi, 0
    ds_write_b64 v48, v[40:41]
    s_lshl_b32 s48, s48, 1
    s_add_u32 s48, s48, 156672
    v_lshl_add_u32 v49, v1, 4, s48
    v_mov_b32 v46, 0
    v_mov_b32 v47, 0
    ds_write_b128 v49, v[44:47]
    s_mov_b32 exec_hi, -1
    v_mov_b32 v62, 161792
    v_mov_b32 v63, 1
    s_mov_b64 exec, 1
    ds_add_u32 v62, v63 offset:64
    s_mov_b64 exec, -1
    v_mov_b32 v62, 161792
L_cw_111:
    ds_read2_b32 v[60:61], v62 offset0:9 offset1:5
    s_waitcnt lgkmcnt(0)
    v_min_u32 v60, v60, v61
    v_cmp_gt_u32 vcc, 4, v60
    s_cbranch_vccz L_cok_112
    s_sleep 1
    s_branch L_cw_111
L_cok_112:
L_else_106:
L_end_33:
    s_cmp_lt_u32 s2, 224
    s_cbranch_scc0 L_else_113
    global_load_dword v8, v6, s[38:39] offset:-4096 sc1
    global_load_dword v9, v6, s[38:39] offset:-3968 sc1
    global_load_dword v10, v6, s[38:39] offset:-3840 sc1
    global_load_dword v11, v6, s[38:39] offset:-3712 sc1
    global_load_dword v12, v6, s[38:39] offset:-3072 sc1
    global_load_dword v13, v6, s[38:39] offset:-2944 sc1
    global_load_dword v14, v6, s[38:39] offset:-2816 sc1
    global_load_dword v15, v6, s[38:39] offset:-2688 sc1
    global_load_dword v16, v6, s[38:39] offset:-2048 sc1
    global_load_dword v17, v6, s[38:39] offset:-1920 sc1
    global_load_dword v18, v6, s[38:39] offset:-1792 sc1
    global_load_dword v19, v6, s[38:39] offset:-1664 sc1
    global_load_dword v20, v6, s[38:39] offset:-1024 sc1
    global_load_dword v21, v6, s[38:39] offset:-896 sc1
    global_load_dword v22, v6, s[38:39] offset:-768 sc1
    global_load_dword v23, v6, s[38:39] offset:-640 sc1
    global_load_dword v24, v6, s[38:39] offset:0 sc1
    global_load_dword v25, v6, s[38:39] offset:128 sc1
    global_load_dword v26, v6, s[38:39] offset:256 sc1
    global_load_dword v27, v6, s[38:39] offset:384 sc1
    global_load_dword v28, v6, s[38:39] offset:1024 sc1
    global_load_dword v29, v6, s[38:39] offset:1152 sc1
    global_load_dword v30, v6, s[38:39] offset:1280 sc1
    global_load_dword v31, v6, s[38:39] offset:1408 sc1
    global_load_dword v32, v6, s[38:39] offset:2048 sc1
    global_load_dword v33, v6, s[38:39] offset:2176 sc1
    global_load_dword v34, v6, s[38:39] offset:2304 sc1
    global_load_dword v35, v6, s[38:39] offset:2432 sc1
    s_waitcnt lgkmcnt(0)
    ds_read_b64_tr_b16 v[40:41], v2 offset:0
    ds_read_b64_tr_b16 v[42:43], v2 offset:512
    ds_read_b64_tr_b16 v[44:45], v3 offset:0
    ds_read_b64_tr_b16 v[46:47], v3 offset:512
    ds_read_b64_tr_b16 v[48:49], v4 offset:0
    ds_read_b64_tr_b16 v[50:51], v4 offset:512
    ds_read_b64_tr_b16 v[52:53], v5 offset:0
    ds_read_b64_tr_b16 v[54:55], v5 offset:512
    s_mul_i32 s48, s63, 114688
    s_lshl_b32 s49, s61, 12
    s_add_u32 s48, s48, s49
    s_add_u32 s48, s48, 9437184
    v_and_b32 v249, 15, v1
    v_lshl_add_u32 v249, v249, 4, s48
    v_bfe_u32 v251, v1, 4, 1
    v_lshl_add_u32 v249, v251, 10, v249
    v_lshrrev_b32 v251, 5, v1
    v_lshl_add_u32 v249, v251, 8, v249
    v_and_b32 v251, 31, v1
    s_lshl_b32 s48, s3, 8
    s_add_u32 s48, s48, 158720
    v_lshl_add_u32 v255, v251, 3, s48
    v_lshlrev_b32 v251, 4, v251
    v_add_u32 v251, 156672, v251
    s_lshl_b32 s48, s43, 2
    s_add_u32 s48, s48, 161856
    v_mov_b32 v254, s48
    s_lshl_b32 s48, s22, 12
    s_lshl_b32 s49, s62, 7
    s_add_u32 s48, s48, s49
    s_add_u32 s48, s48, 19136512
    v_and_b32 v250, 3, v1
    v_lshl_add_u32 v250, v250, 7, s48
    s_cmp_eq_u32 s43, 1
    s_cbranch_scc0 L_else_116
    s_setprio 1
L_else_116:
    s_waitcnt vmcnt(24) lgkmcnt(6)
    v_mfma_f32_32x32x16_bf16 v[72:87], v[40:43], v[8:11], 0
    ds_read_b64_tr_b16 v[56:57], v2 offset:4096
    ds_read_b64_tr_b16 v[58:59], v2 offset:4608
    global_load_dword v36, v6, s[38:39] offset:3072 sc1
    s_waitcnt lgkmcnt(6)
    v_mfma_f32_32x32x16_bf16 v[88:103], v[44:47], v[8:11], 0
    ds_read_b64_tr_b16 v[60:61], v3 offset:4096
    ds_read_b64_tr_b16 v[62:63], v3 offset:4608
    global_load_dword v37, v6, s[38:39] offset:3200 sc1
    s_waitcnt lgkmcnt(6)
    v_mfma_f32_32x32x16_bf16 v[104:119], v[48:51], v[8:11], 0
    ds_read_b64_tr_b16 v[64:65], v4 offset:4096
    ds_read_b64_tr_b16 v[66:67], v4 offset:4608
    global_load_dword v38, v6, s[38:39] offset:3328 sc1
    s_waitcnt lgkmcnt(6)
    v_mfma_f32_32x32x16_bf16 v[120:135], v[52:55], v[8:11], 0
    ds_read_b64_tr_b16 v[68:69], v5 offset:4096
    ds_read_b64_tr_b16 v[70:71], v5 offset:4608
    global_load_dword v39, v6, s[38:39] offset:3456 sc1
    s_waitcnt vmcnt(24) lgkmcnt(6)
    v_mfma_f32_32x32x16_bf16 v[72:87], v[56:59], v[12:15], v[72:87]
    ds_read_b64_tr_b16 v[40:41], v2 offset:8192
    ds_read_b64_tr_b16 v[42:43], v2 offset:8704
    v_add_u32 v6, 8192, v6
    global_load_dword v8, v6, s[38:39] offset:-4096 sc1
    s_waitcnt lgkmcnt(6)
    v_mfma_f32_32x32x16_bf16 v[88:103], v[60:63], v[12:15], v[88:103]
    ds_read_b64_tr_b16 v[44:45], v3 offset:8192
    ds_read_b64_tr_b16 v[46:47], v3 offset:8704
    global_load_dword v9, v6, s[38:39] offset:-3968 sc1
    s_waitcnt lgkmcnt(6)
    v_mfma_f32_32x32x16_bf16 v[104:119], v[64:67], v[12:15], v[104:119]
    ds_read_b64_tr_b16 v[48:49], v4 offset:8192
    ds_read_b64_tr_b16 v[50:51], v4 offset:8704
    global_load_dword v10, v6, s[38:39] offset:-3840 sc1
    s_waitcnt lgkmcnt(6)
    v_mfma_f32_32x32x16_bf16 v[120:135], v[68:71], v[12:15], v[120:135]
    ds_read_b64_tr_b16 v[52:53], v5 offset:8192
    ds_read_b64_tr_b16 v[54:55], v5 offset:8704
    global_load_dword v11, v6, s[38:39] offset:-3712 sc1
    s_waitcnt vmcnt(24) lgkmcnt(6)
    v_mfma_f32_32x32x16_bf16 v[72:87], v[40:43], v[16:19], v[72:87]
    ds_read_b64_tr_b16 v[56:57], v2 offset:12288
    ds_read_b64_tr_b16 v[58:59], v2 offset:12800
    global_load_dword v12, v6, s[38:39] offset:-3072 sc1
    s_waitcnt lgkmcnt(6)
    v_mfma_f32_32x32x16_bf16 v[88:103], v[44:47], v[16:19], v[88:103]
    ds_read_b64_tr_b16 v[60:61], v3 offset:12288
    ds_read_b64_tr_b16 v[62:63], v3 offset:12800
    global_load_dword v13, v6, s[38:39] offset:-2944 sc1
    s_waitcnt lgkmcnt(6)
    v_mfma_f32_32x32x16_bf16 v[104:119], v[48:51], v[16:19], v[104:119]
    ds_read_b64_tr_b16 v[64:65], v4 offset:12288
    ds_read_b64_tr_b16 v[66:67], v4 offset:12800
    global_load_dword v14, v6, s[38:39] offset:-2816 sc1
    s_waitcnt lgkmcnt(6)
    v_mfma_f32_32x32x16_bf16 v[120:135], v[52:55], v[16:19], v[120:135]
    ds_read_b64_tr_b16 v[68:69], v5 offset:12288
    ds_read_b64_tr_b16 v[70:71], v5 offset:12800
    global_load_dword v15, v6, s[38:39] offset:-2688 sc1
    s_waitcnt vmcnt(24) lgkmcnt(6)
    v_mfma_f32_32x32x16_bf16 v[72:87], v[56:59], v[20:23], v[72:87]
    ds_read_b64_tr_b16 v[40:41], v2 offset:16384
    ds_read_b64_tr_b16 v[42:43], v2 offset:16896
    global_load_dword v16, v6, s[38:39] offset:-2048 sc1
    s_waitcnt lgkmcnt(6)
    v_mfma_f32_32x32x16_bf16 v[88:103], v[60:63], v[20:23], v[88:103]
    ds_read_b64_tr_b16 v[44:45], v3 offset:16384
    ds_read_b64_tr_b16 v[46:47], v3 offset:16896
    global_load_dword v17, v6, s[38:39] offset:-1920 sc1
    s_waitcnt lgkmcnt(6)
    v_mfma_f32_32x32x16_bf16 v[104:119], v[64:67], v[20:23], v[104:119]
    ds_read_b64_tr_b16 v[48:49], v4 offset:16384
    ds_read_b64_tr_b16 v[50:51], v4 offset:16896
    global_load_dword v18, v6, s[38:39] offset:-1792 sc1
    s_waitcnt lgkmcnt(6)
    v_mfma_f32_32x32x16_bf16 v[120:135], v[68:71], v[20:23], v[120:135]
    ds_read_b64_tr_b16 v[52:53], v5 offset:16384
    ds_read_b64_tr_b16 v[54:55], v5 offset:16896
    global_load_dword v19, v6, s[38:39] offset:-1664 sc1
    s_waitcnt vmcnt(24) lgkmcnt(6)
    v_mfma_f32_32x32x16_bf16 v[72:87], v[40:43], v[24:27], v[72:87]
    ds_read_b64_tr_b16 v[56:57], v2 offset:20480
    ds_read_b64_tr_b16 v[58:59], v2 offset:20992
    global_load_dword v20, v6, s[38:39] offset:-1024 sc1
    s_waitcnt lgkmcnt(6)
    v_mfma_f32_32x32x16_bf16 v[88:103], v[44:47], v[24:27], v[88:103]
    ds_read_b64_tr_b16 v[60:61], v3 offset:20480
    ds_read_b64_tr_b16 v[62:63], v3 offset:20992
    global_load_dword v21, v6, s[38:39] offset:-896 sc1
    s_waitcnt lgkmcnt(6)
    v_mfma_f32_32x32x16_bf16 v[104:119], v[48:51], v[24:27], v[104:119]
    ds_read_b64_tr_b16 v[64:65], v4 offset:20480
    ds_read_b64_tr_b16 v[66:67], v4 offset:20992
    global_load_dword v22, v6, s[38:39] offset:-768 sc1
    s_waitcnt lgkmcnt(6)
    v_mfma_f32_32x32x16_bf16 v[120:135], v[52:55], v[24:27], v[120:135]
    ds_read_b64_tr_b16 v[68:69], v5 offset:20480
    ds_read_b64_tr_b16 v[70:71], v5 offset:20992
    global_load_dword v23, v6, s[38:39] offset:-640 sc1
    s_waitcnt vmcnt(24) lgkmcnt(6)
    v_mfma_f32_32x32x16_bf16 v[72:87], v[56:59], v[28:31], v[72:87]
    ds_read_b64_tr_b16 v[40:41], v2 offset:24576
    ds_read_b64_tr_b16 v[42:43], v2 offset:25088
    global_load_dword v24, v6, s[38:39] offset:0 sc1
    s_waitcnt lgkmcnt(6)
    v_mfma_f32_32x32x16_bf16 v[88:103], v[60:63], v[28:31], v[88:103]
    ds_read_b64_tr_b16 v[44:45], v3 offset:24576
    ds_read_b64_tr_b16 v[46:47], v3 offset:25088
    global_load_dword v25, v6, s[38:39] offset:128 sc1
    s_waitcnt lgkmcnt(6)
    v_mfma_f32_32x32x16_bf16 v[104:119], v[64:67], v[28:31], v[104:119]
    ds_read_b64_tr_b16 v[48:49], v4 offset:24576
    ds_read_b64_tr_b16 v[50:51], v4 offset:25088
    global_load_dword v26, v6, s[38:39] offset:256 sc1
    s_waitcnt lgkmcnt(6)
    v_mfma_f32_32x32x16_bf16 v[120:135], v[68:71], v[28:31], v[120:135]
    ds_read_b64_tr_b16 v[52:53], v5 offset:24576
    ds_read_b64_tr_b16 v[54:55], v5 offset:25088
    global_load_dword v27, v6, s[38:39] offset:384 sc1
    s_waitcnt vmcnt(24) lgkmcnt(6)
    v_mfma_f32_32x32x16_bf16 v[72:87], v[40:43], v[32:35], v[72:87]
    ds_read_b64_tr_b16 v[56:57], v2 offset:28672
    ds_read_b64_tr_b16 v[58:59], v2 offset:29184
    global_load_dword v28, v6, s[38:39] offset:1024 sc1
    s_waitcnt lgkmcnt(6)
    v_mfma_f32_32x32x16_bf16 v[88:103], v[44:47], v[32:35], v[88:103]
    ds_read_b64_tr_b16 v[60:61], v3 offset:28672
    ds_read_b64_tr_b16 v[62:63], v3 offset:29184
    global_load_dword v29, v6, s[38:39] offset:1152 sc1
    s_waitcnt lgkmcnt(6)
    v_mfma_f32_32x32x16_bf16 v[104:119], v[48:51], v[32:35], v[104:119]
    ds_read_b64_tr_b16 v[64:65], v4 offset:28672
    ds_read_b64_tr_b16 v[66:67], v4 offset:29184
    global_load_dword v30, v6, s[38:39] offset:1280 sc1
    s_waitcnt lgkmcnt(6)
    v_mfma_f32_32x32x16_bf16 v[120:135], v[52:55], v[32:35], v[120:135]
    ds_read_b64_tr_b16 v[68:69], v5 offset:28672
    ds_read_b64_tr_b16 v[70:71], v5 offset:29184
    global_load_dword v31, v6, s[38:39] offset:1408 sc1
    s_waitcnt vmcnt(24) lgkmcnt(6)
    v_mfma_f32_32x32x16_bf16 v[72:87], v[56:59], v[36:39], v[72:87]
    ds_read_b64_tr_b16 v[40:41], v2 offset:32768
    ds_read_b64_tr_b16 v[42:43], v2 offset:33280
    global_load_dword v32, v6, s[38:39] offset:2048 sc1
    s_waitcnt lgkmcnt(6)
    v_mfma_f32_32x32x16_bf16 v[88:103], v[60:63], v[36:39], v[88:103]
    ds_read_b64_tr_b16 v[44:45], v3 offset:32768
    ds_read_b64_tr_b16 v[46:47], v3 offset:33280
    global_load_dword v33, v6, s[38:39] offset:2176 sc1
    s_waitcnt lgkmcnt(6)
    v_mfma_f32_32x32x16_bf16 v[104:119], v[64:67], v[36:39], v[104:119]
    ds_read_b64_tr_b16 v[48:49], v4 offset:32768
    ds_read_b64_tr_b16 v[50:51], v4 offset:33280
    global_load_dword v34, v6, s[38:39] offset:2304 sc1
    s_waitcnt lgkmcnt(6)
    v_mfma_f32_32x32x16_bf16 v[120:135], v[68:71], v[36:39], v[120:135]
    ds_read_b64_tr_b16 v[52:53], v5 offset:32768
    ds_read_b64_tr_b16 v[54:55], v5 offset:33280
    global_load_dword v35, v6, s[38:39] offset:2432 sc1
    s_waitcnt vmcnt(24) lgkmcnt(6)
    v_mfma_f32_32x32x16_bf16 v[72:87], v[40:43], v[8:11], v[72:87]
    ds_read_b64_tr_b16 v[56:57], v2 offset:36864
    ds_read_b64_tr_b16 v[58:59], v2 offset:37376
    global_load_dword v36, v6, s[38:39] offset:3072 sc1
    s_waitcnt lgkmcnt(6)
    v_mfma_f32_32x32x16_bf16 v[88:103], v[44:47], v[8:11], v[88:103]
    ds_read_b64_tr_b16 v[60:61], v3 offset:36864
    ds_read_b64_tr_b16 v[62:63], v3 offset:37376
    global_load_dword v37, v6, s[38:39] offset:3200 sc1
    s_waitcnt lgkmcnt(6)
    v_mfma_f32_32x32x16_bf16 v[104:119], v[48:51], v[8:11], v[104:119]
    ds_read_b64_tr_b16 v[64:65], v4 offset:36864
    ds_read_b64_tr_b16 v[66:67], v4 offset:37376
    global_load_dword v38, v6, s[38:39] offset:3328 sc1
    s_waitcnt lgkmcnt(6)
    v_mfma_f32_32x32x16_bf16 v[120:135], v[52:55], v[8:11], v[120:135]
    ds_read_b64_tr_b16 v[68:69], v5 offset:36864
    ds_read_b64_tr_b16 v[70:71], v5 offset:37376
    global_load_dword v39, v6, s[38:39] offset:3456 sc1
    s_waitcnt vmcnt(24) lgkmcnt(6)
    v_mfma_f32_32x32x16_bf16 v[72:87], v[56:59], v[12:15], v[72:87]
    ds_read_b64_tr_b16 v[40:41], v2 offset:40960
    ds_read_b64_tr_b16 v[42:43], v2 offset:41472
    v_add_u32 v6, 8192, v6
    global_load_dword v8, v6, s[38:39] offset:-4096 sc1
    s_waitcnt lgkmcnt(6)
    v_mfma_f32_32x32x16_bf16 v[88:103], v[60:63], v[12:15], v[88:103]
    ds_read_b64_tr_b16 v[44:45], v3 offset:40960
    ds_read_b64_tr_b16 v[46:47], v3 offset:41472
    global_load_dword v9, v6, s[38:39] offset:-3968 sc1
    s_waitcnt lgkmcnt(6)
    v_mfma_f32_32x32x16_bf16 v[104:119], v[64:67], v[12:15], v[104:119]
    ds_read_b64_tr_b16 v[48:49], v4 offset:40960
    ds_read_b64_tr_b16 v[50:51], v4 offset:41472
    global_load_dword v10, v6, s[38:39] offset:-3840 sc1
    s_waitcnt lgkmcnt(6)
    v_mfma_f32_32x32x16_bf16 v[120:135], v[68:71], v[12:15], v[120:135]
    ds_read_b64_tr_b16 v[52:53], v5 offset:40960
    ds_read_b64_tr_b16 v[54:55], v5 offset:41472
    global_load_dword v11, v6, s[38:39] offset:-3712 sc1
    s_waitcnt vmcnt(24) lgkmcnt(6)
    v_mfma_f32_32x32x16_bf16 v[72:87], v[40:43], v[16:19], v[72:87]
    ds_read_b64_tr_b16 v[56:57], v2 offset:45056
    ds_read_b64_tr_b16 v[58:59], v2 offset:45568
    global_load_dword v12, v6, s[38:39] offset:-3072 sc1
    s_waitcnt lgkmcnt(6)
    v_mfma_f32_32x32x16_bf16 v[88:103], v[44:47], v[16:19], v[88:103]
    ds_read_b64_tr_b16 v[60:61], v3 offset:45056
    ds_read_b64_tr_b16 v[62:63], v3 offset:45568
    global_load_dword v13, v6, s[38:39] offset:-2944 sc1
    s_waitcnt lgkmcnt(6)
    v_mfma_f32_32x32x16_bf16 v[104:119], v[48:51], v[16:19], v[104:119]
    ds_read_b64_tr_b16 v[64:65], v4 offset:45056
    ds_read_b64_tr_b16 v[66:67], v4 offset:45568
    global_load_dword v14, v6, s[38:39] offset:-2816 sc1
    s_waitcnt lgkmcnt(6)
    v_mfma_f32_32x32x16_bf16 v[120:135], v[52:55], v[16:19], v[120:135]
    ds_read_b64_tr_b16 v[68:69], v5 offset:45056
    ds_read_b64_tr_b16 v[70:71], v5 offset:45568
    global_load_dword v15, v6, s[38:39] offset:-2688 sc1
    s_waitcnt vmcnt(24) lgkmcnt(6)
    v_mfma_f32_32x32x16_bf16 v[72:87], v[56:59], v[20:23], v[72:87]
    ds_read_b64_tr_b16 v[40:41], v2 offset:49152
    ds_read_b64_tr_b16 v[42:43], v2 offset:49664
    global_load_dword v16, v6, s[38:39] offset:-2048 sc1
    s_waitcnt lgkmcnt(6)
    v_mfma_f32_32x32x16_bf16 v[88:103], v[60:63], v[20:23], v[88:103]
    ds_read_b64_tr_b16 v[44:45], v3 offset:49152
    ds_read_b64_tr_b16 v[46:47], v3 offset:49664
    global_load_dword v17, v6, s[38:39] offset:-1920 sc1
    s_waitcnt lgkmcnt(6)
    v_mfma_f32_32x32x16_bf16 v[104:119], v[64:67], v[20:23], v[104:119]
    ds_read_b64_tr_b16 v[48:49], v4 offset:49152
    ds_read_b64_tr_b16 v[50:51], v4 offset:49664
    global_load_dword v18, v6, s[38:39] offset:-1792 sc1
    s_waitcnt lgkmcnt(6)
    v_mfma_f32_32x32x16_bf16 v[120:135], v[68:71], v[20:23], v[120:135]
    ds_read_b64_tr_b16 v[52:53], v5 offset:49152
    ds_read_b64_tr_b16 v[54:55], v5 offset:49664
    global_load_dword v19, v6, s[38:39] offset:-1664 sc1
    s_waitcnt vmcnt(24) lgkmcnt(6)
    v_mfma_f32_32x32x16_bf16 v[72:87], v[40:43], v[24:27], v[72:87]
    ds_read_b64_tr_b16 v[56:57], v2 offset:53248
    ds_read_b64_tr_b16 v[58:59], v2 offset:53760
    global_load_dword v20, v6, s[38:39] offset:-1024 sc1
    s_waitcnt lgkmcnt(6)
    v_mfma_f32_32x32x16_bf16 v[88:103], v[44:47], v[24:27], v[88:103]
    ds_read_b64_tr_b16 v[60:61], v3 offset:53248
    ds_read_b64_tr_b16 v[62:63], v3 offset:53760
    global_load_dword v21, v6, s[38:39] offset:-896 sc1
    s_waitcnt lgkmcnt(6)
    v_mfma_f32_32x32x16_bf16 v[104:119], v[48:51], v[24:27], v[104:119]
    ds_read_b64_tr_b16 v[64:65], v4 offset:53248
    ds_read_b64_tr_b16 v[66:67], v4 offset:53760
    global_load_dword v22, v6, s[38:39] offset:-768 sc1
    s_waitcnt lgkmcnt(6)
    v_mfma_f32_32x32x16_bf16 v[120:135], v[52:55], v[24:27], v[120:135]
    ds_read_b64_tr_b16 v[68:69], v5 offset:53248
    ds_read_b64_tr_b16 v[70:71], v5 offset:53760
    global_load_dword v23, v6, s[38:39] offset:-640 sc1
    s_waitcnt vmcnt(24) lgkmcnt(6)
    v_mfma_f32_32x32x16_bf16 v[72:87], v[56:59], v[28:31], v[72:87]
    ds_read_b64_tr_b16 v[40:41], v2 offset:57344
    ds_read_b64_tr_b16 v[42:43], v2 offset:57856
    global_load_dword v24, v6, s[38:39] offset:0 sc1
    s_waitcnt lgkmcnt(6)
    v_mfma_f32_32x32x16_bf16 v[88:103], v[60:63], v[28:31], v[88:103]
    ds_read_b64_tr_b16 v[44:45], v3 offset:57344
    ds_read_b64_tr_b16 v[46:47], v3 offset:57856
    global_load_dword v25, v6, s[38:39] offset:128 sc1
    s_waitcnt lgkmcnt(6)
    v_mfma_f32_32x32x16_bf16 v[104:119], v[64:67], v[28:31], v[104:119]
    ds_read_b64_tr_b16 v[48:49], v4 offset:57344
    ds_read_b64_tr_b16 v[50:51], v4 offset:57856
    global_load_dword v26, v6, s[38:39] offset:256 sc1
    s_waitcnt lgkmcnt(6)
    v_mfma_f32_32x32x16_bf16 v[120:135], v[68:71], v[28:31], v[120:135]
    ds_read_b64_tr_b16 v[52:53], v5 offset:57344
    ds_read_b64_tr_b16 v[54:55], v5 offset:57856
    global_load_dword v27, v6, s[38:39] offset:384 sc1
    s_waitcnt vmcnt(24) lgkmcnt(6)
    v_mfma_f32_32x32x16_bf16 v[72:87], v[40:43], v[32:35], v[72:87]
    ds_read_b64_tr_b16 v[56:57], v2 offset:61440
    ds_read_b64_tr_b16 v[58:59], v2 offset:61952
    global_load_dword v28, v6, s[38:39] offset:1024 sc1
    s_waitcnt lgkmcnt(6)
    v_mfma_f32_32x32x16_bf16 v[88:103], v[44:47], v[32:35], v[88:103]
    ds_read_b64_tr_b16 v[60:61], v3 offset:61440
    ds_read_b64_tr_b16 v[62:63], v3 offset:61952
    global_load_dword v29, v6, s[38:39] offset:1152 sc1
    s_waitcnt lgkmcnt(6)
    v_mfma_f32_32x32x16_bf16 v[104:119], v[48:51], v[32:35], v[104:119]
    ds_read_b64_tr_b16 v[64:65], v4 offset:61440
    ds_read_b64_tr_b16 v[66:67], v4 offset:61952
    global_load_dword v30, v6, s[38:39] offset:1280 sc1
    s_waitcnt lgkmcnt(6)
    v_mfma_f32_32x32x16_bf16 v[120:135], v[52:55], v[32:35], v[120:135]
    ds_read_b64_tr_b16 v[68:69], v5 offset:61440
    ds_read_b64_tr_b16 v[70:71], v5 offset:61952
    global_load_dword v31, v6, s[38:39] offset:1408 sc1
    s_waitcnt vmcnt(24) lgkmcnt(6)
    v_mfma_f32_32x32x16_bf16 v[72:87], v[56:59], v[36:39], v[72:87]
    v_add_u32 v2, 0x10000, v2
    ds_read_b64_tr_b16 v[40:41], v2 offset:0
    ds_read_b64_tr_b16 v[42:43], v2 offset:512
    global_load_dword v32, v6, s[38:39] offset:2048 sc1
    s_waitcnt lgkmcnt(6)
    v_mfma_f32_32x32x16_bf16 v[88:103], v[60:63], v[36:39], v[88:103]
    v_add_u32 v3, 0x10000, v3
    ds_read_b64_tr_b16 v[44:45], v3 offset:0
    ds_read_b64_tr_b16 v[46:47], v3 offset:512
    global_load_dword v33, v6, s[38:39] offset:2176 sc1
    s_waitcnt lgkmcnt(6)
    v_mfma_f32_32x32x16_bf16 v[104:119], v[64:67], v[36:39], v[104:119]
    v_add_u32 v4, 0x10000, v4
    ds_read_b64_tr_b16 v[48:49], v4 offset:0
    ds_read_b64_tr_b16 v[50:51], v4 offset:512
    global_load_dword v34, v6, s[38:39] offset:2304 sc1
    s_waitcnt lgkmcnt(6)
    v_mfma_f32_32x32x16_bf16 v[120:135], v[68:71], v[36:39], v[120:135]
    v_add_u32 v5, 0x10000, v5
    ds_read_b64_tr_b16 v[52:53], v5 offset:0
    ds_read_b64_tr_b16 v[54:55], v5 offset:512
    global_load_dword v35, v6, s[38:39] offset:2432 sc1
    s_waitcnt vmcnt(24) lgkmcnt(6)
    v_mfma_f32_32x32x16_bf16 v[72:87], v[40:43], v[8:11], v[72:87]
    ds_read_b64_tr_b16 v[56:57], v2 offset:4096
    ds_read_b64_tr_b16 v[58:59], v2 offset:4608
    global_load_dword v36, v6, s[38:39] offset:3072 sc1
    s_waitcnt lgkmcnt(6)
    v_mfma_f32_32x32x16_bf16 v[88:103], v[44:47], v[8:11], v[88:103]
    ds_read_b64_tr_b16 v[60:61], v3 offset:4096
    ds_read_b64_tr_b16 v[62:63], v3 offset:4608
    global_load_dword v37, v6, s[38:39] offset:3200 sc1
    s_waitcnt lgkmcnt(6)
    v_mfma_f32_32x32x16_bf16 v[104:119], v[48:51], v[8:11], v[104:119]
    ds_read_b64_tr_b16 v[64:65], v4 offset:4096
    ds_read_b64_tr_b16 v[66:67], v4 offset:4608
    global_load_dword v38, v6, s[38:39] offset:3328 sc1
    s_waitcnt lgkmcnt(6)
    v_mfma_f32_32x32x16_bf16 v[120:135], v[52:55], v[8:11], v[120:135]
    ds_read_b64_tr_b16 v[68:69], v5 offset:4096
    ds_read_b64_tr_b16 v[70:71], v5 offset:4608
    global_load_dword v39, v6, s[38:39] offset:3456 sc1
    s_waitcnt vmcnt(24) lgkmcnt(6)
    v_mfma_f32_32x32x16_bf16 v[72:87], v[56:59], v[12:15], v[72:87]
    ds_read_b64_tr_b16 v[40:41], v2 offset:8192
    ds_read_b64_tr_b16 v[42:43], v2 offset:8704
    v_add_u32 v6, 8192, v6
    global_load_dword v8, v6, s[38:39] offset:-4096 sc1
    s_waitcnt lgkmcnt(6)
    v_mfma_f32_32x32x16_bf16 v[88:103], v[60:63], v[12:15], v[88:103]
    ds_read_b64_tr_b16 v[44:45], v3 offset:8192
    ds_read_b64_tr_b16 v[46:47], v3 offset:8704
    global_load_dword v9, v6, s[38:39] offset:-3968 sc1
    s_waitcnt lgkmcnt(6)
    v_mfma_f32_32x32x16_bf16 v[104:119], v[64:67], v[12:15], v[104:119]
    ds_read_b64_tr_b16 v[48:49], v4 offset:8192
    ds_read_b64_tr_b16 v[50:51], v4 offset:8704
    global_load_dword v10, v6, s[38:39] offset:-3840 sc1
    s_waitcnt lgkmcnt(6)
    v_mfma_f32_32x32x16_bf16 v[120:135], v[68:71], v[12:15], v[120:135]
    ds_read_b64_tr_b16 v[52:53], v5 offset:8192
    ds_read_b64_tr_b16 v[54:55], v5 offset:8704
    global_load_dword v11, v6, s[38:39] offset:-3712 sc1
    s_waitcnt vmcnt(24) lgkmcnt(6)
    v_mfma_f32_32x32x16_bf16 v[72:87], v[40:43], v[16:19], v[72:87]
    ds_read_b64_tr_b16 v[56:57], v2 offset:12288
    ds_read_b64_tr_b16 v[58:59], v2 offset:12800
    global_load_dword v12, v6, s[38:39] offset:-3072 sc1
    s_waitcnt lgkmcnt(6)
    v_mfma_f32_32x32x16_bf16 v[88:103], v[44:47], v[16:19], v[88:103]
    ds_read_b64_tr_b16 v[60:61], v3 offset:12288
    ds_read_b64_tr_b16 v[62:63], v3 offset:12800
    global_load_dword v13, v6, s[38:39] offset:-2944 sc1
    s_waitcnt lgkmcnt(6)
    v_mfma_f32_32x32x16_bf16 v[104:119], v[48:51], v[16:19], v[104:119]
    ds_read_b64_tr_b16 v[64:65], v4 offset:12288
    ds_read_b64_tr_b16 v[66:67], v4 offset:12800
    global_load_dword v14, v6, s[38:39] offset:-2816 sc1
    s_waitcnt lgkmcnt(6)
    v_mfma_f32_32x32x16_bf16 v[120:135], v[52:55], v[16:19], v[120:135]
    ds_read_b64_tr_b16 v[68:69], v5 offset:12288
    ds_read_b64_tr_b16 v[70:71], v5 offset:12800
    global_load_dword v15, v6, s[38:39] offset:-2688 sc1
    s_waitcnt vmcnt(24) lgkmcnt(6)
    v_mfma_f32_32x32x16_bf16 v[72:87], v[56:59], v[20:23], v[72:87]
    ds_read_b64_tr_b16 v[40:41], v2 offset:16384
    ds_read_b64_tr_b16 v[42:43], v2 offset:16896
    global_load_dword v16, v6, s[38:39] offset:-2048 sc1
    s_waitcnt lgkmcnt(6)
    v_mfma_f32_32x32x16_bf16 v[88:103], v[60:63], v[20:23], v[88:103]
    ds_read_b64_tr_b16 v[44:45], v3 offset:16384
    ds_read_b64_tr_b16 v[46:47], v3 offset:16896
    global_load_dword v17, v6, s[38:39] offset:-1920 sc1
    s_waitcnt lgkmcnt(6)
    v_mfma_f32_32x32x16_bf16 v[104:119], v[64:67], v[20:23], v[104:119]
    ds_read_b64_tr_b16 v[48:49], v4 offset:16384
    ds_read_b64_tr_b16 v[50:51], v4 offset:16896
    global_load_dword v18, v6, s[38:39] offset:-1792 sc1
    s_waitcnt lgkmcnt(6)
    v_mfma_f32_32x32x16_bf16 v[120:135], v[68:71], v[20:23], v[120:135]
    ds_read_b64_tr_b16 v[52:53], v5 offset:16384
    ds_read_b64_tr_b16 v[54:55], v5 offset:16896
    global_load_dword v19, v6, s[38:39] offset:-1664 sc1
    s_cmp_eq_u32 s43, 1
    s_cbranch_scc0 L_else_118
    s_mov_b64 exec, 15
    v_mov_b32 v252, 0
    v_mov_b32 v253, 0
    global_atomic_add_x2 v[252:253], v250, v[252:253], s[38:39] sc0 sc1
    s_mov_b64 exec, -1
    s_branch L_end_119
L_else_118:
    global_load_dwordx4 v[192:195], v248, s[38:39] offset:2048 sc1
L_end_119:
    s_waitcnt vmcnt(25) lgkmcnt(6)
    v_mfma_f32_32x32x16_bf16 v[72:87], v[40:43], v[24:27], v[72:87]
    ds_read_b64_tr_b16 v[56:57], v2 offset:20480
    ds_read_b64_tr_b16 v[58:59], v2 offset:20992
    global_load_dword v20, v6, s[38:39] offset:-1024 sc1
    s_waitcnt lgkmcnt(6)
    v_mfma_f32_32x32x16_bf16 v[88:103], v[44:47], v[24:27], v[88:103]
    ds_read_b64_tr_b16 v[60:61], v3 offset:20480
    ds_read_b64_tr_b16 v[62:63], v3 offset:20992
    global_load_dword v21, v6, s[38:39] offset:-896 sc1
    s_waitcnt lgkmcnt(6)
    v_mfma_f32_32x32x16_bf16 v[104:119], v[48:51], v[24:27], v[104:119]
    ds_read_b64_tr_b16 v[64:65], v4 offset:20480
    ds_read_b64_tr_b16 v[66:67], v4 offset:20992
    global_load_dword v22, v6, s[38:39] offset:-768 sc1
    s_waitcnt lgkmcnt(6)
    v_mfma_f32_32x32x16_bf16 v[120:135], v[52:55], v[24:27], v[120:135]
    ds_read_b64_tr_b16 v[68:69], v5 offset:20480
    ds_read_b64_tr_b16 v[70:71], v5 offset:20992
    global_load_dword v23, v6, s[38:39] offset:-640 sc1
    s_waitcnt vmcnt(25) lgkmcnt(6)
    v_mfma_f32_32x32x16_bf16 v[72:87], v[56:59], v[28:31], v[72:87]
    ds_read_b64_tr_b16 v[40:41], v2 offset:24576
    ds_read_b64_tr_b16 v[42:43], v2 offset:25088
    global_load_dword v24, v6, s[38:39] offset:0 sc1
    s_waitcnt lgkmcnt(6)
    v_mfma_f32_32x32x16_bf16 v[88:103], v[60:63], v[28:31], v[88:103]
    ds_read_b64_tr_b16 v[44:45], v3 offset:24576
    ds_read_b64_tr_b16 v[46:47], v3 offset:25088
    global_load_dword v25, v6, s[38:39] offset:128 sc1
    s_waitcnt lgkmcnt(6)
    v_mfma_f32_32x32x16_bf16 v[104:119], v[64:67], v[28:31], v[104:119]
    ds_read_b64_tr_b16 v[48:49], v4 offset:24576
    ds_read_b64_tr_b16 v[50:51], v4 offset:25088
    global_load_dword v26, v6, s[38:39] offset:256 sc1
    s_waitcnt lgkmcnt(6)
    v_mfma_f32_32x32x16_bf16 v[120:135], v[68:71], v[28:31], v[120:135]
    ds_read_b64_tr_b16 v[52:53], v5 offset:24576
    ds_read_b64_tr_b16 v[54:55], v5 offset:25088
    global_load_dword v27, v6, s[38:39] offset:384 sc1
    s_waitcnt vmcnt(25) lgkmcnt(6)
    v_mfma_f32_32x32x16_bf16 v[72:87], v[40:43], v[32:35], v[72:87]
    ds_read_b64_tr_b16 v[56:57], v2 offset:28672
    ds_read_b64_tr_b16 v[58:59], v2 offset:29184
    global_load_dword v28, v6, s[38:39] offset:1024 sc1
    s_waitcnt lgkmcnt(6)
    v_mfma_f32_32x32x16_bf16 v[88:103], v[44:47], v[32:35], v[88:103]
    ds_read_b64_tr_b16 v[60:61], v3 offset:28672
    ds_read_b64_tr_b16 v[62:63], v3 offset:29184
    global_load_dword v29, v6, s[38:39] offset:1152 sc1
    s_waitcnt lgkmcnt(6)
    v_mfma_f32_32x32x16_bf16 v[104:119], v[48:51], v[32:35], v[104:119]
    ds_read_b64_tr_b16 v[64:65], v4 offset:28672
    ds_read_b64_tr_b16 v[66:67], v4 offset:29184
    global_load_dword v30, v6, s[38:39] offset:1280 sc1
    s_waitcnt lgkmcnt(6)
    v_mfma_f32_32x32x16_bf16 v[120:135], v[52:55], v[32:35], v[120:135]
    ds_read_b64_tr_b16 v[68:69], v5 offset:28672
    ds_read_b64_tr_b16 v[70:71], v5 offset:29184
    global_load_dword v31, v6, s[38:39] offset:1408 sc1
    s_waitcnt vmcnt(25) lgkmcnt(6)
    v_mfma_f32_32x32x16_bf16 v[72:87], v[56:59], v[36:39], v[72:87]
    ds_read_b64_tr_b16 v[40:41], v2 offset:32768
    ds_read_b64_tr_b16 v[42:43], v2 offset:33280
    global_load_dword v32, v6, s[38:39] offset:2048 sc1
    s_waitcnt lgkmcnt(6)
    v_mfma_f32_32x32x16_bf16 v[88:103], v[60:63], v[36:39], v[88:103]
    ds_read_b64_tr_b16 v[44:45], v3 offset:32768
    ds_read_b64_tr_b16 v[46:47], v3 offset:33280
    global_load_dword v33, v6, s[38:39] offset:2176 sc1
    s_waitcnt lgkmcnt(6)
    v_mfma_f32_32x32x16_bf16 v[104:119], v[64:67], v[36:39], v[104:119]
    ds_read_b64_tr_b16 v[48:49], v4 offset:32768
    ds_read_b64_tr_b16 v[50:51], v4 offset:33280
    global_load_dword v34, v6, s[38:39] offset:2304 sc1
    s_waitcnt lgkmcnt(6)
    v_mfma_f32_32x32x16_bf16 v[120:135], v[68:71], v[36:39], v[120:135]
    ds_read_b64_tr_b16 v[52:53], v5 offset:32768
    ds_read_b64_tr_b16 v[54:55], v5 offset:33280
    global_load_dword v35, v6, s[38:39] offset:2432 sc1
    s_waitcnt vmcnt(25) lgkmcnt(6)
    v_mfma_f32_32x32x16_bf16 v[72:87], v[40:43], v[8:11], v[72:87]
    ds_read_b64_tr_b16 v[56:57], v2 offset:36864
    ds_read_b64_tr_b16 v[58:59], v2 offset:37376
    global_load_dword v36, v6, s[38:39] offset:3072 sc1
    s_waitcnt lgkmcnt(6)
    v_mfma_f32_32x32x16_bf16 v[88:103], v[44:47], v[8:11], v[88:103]
    ds_read_b64_tr_b16 v[60:61], v3 offset:36864
    ds_read_b64_tr_b16 v[62:63], v3 offset:37376
    global_load_dword v37, v6, s[38:39] offset:3200 sc1
    s_waitcnt lgkmcnt(6)
    v_mfma_f32_32x32x16_bf16 v[104:119], v[48:51], v[8:11], v[104:119]
    ds_read_b64_tr_b16 v[64:65], v4 offset:36864
    ds_read_b64_tr_b16 v[66:67], v4 offset:37376
    global_load_dword v38, v6, s[38:39] offset:3328 sc1
    s_waitcnt lgkmcnt(6)
    v_mfma_f32_32x32x16_bf16 v[120:135], v[52:55], v[8:11], v[120:135]
    ds_read_b64_tr_b16 v[68:69], v5 offset:36864
    ds_read_b64_tr_b16 v[70:71], v5 offset:37376
    global_load_dword v39, v6, s[38:39] offset:3456 sc1
    s_waitcnt vmcnt(25) lgkmcnt(6)
    v_mfma_f32_32x32x16_bf16 v[72:87], v[56:59], v[12:15], v[72:87]
    ds_read_b64_tr_b16 v[40:41], v2 offset:40960
    ds_read_b64_tr_b16 v[42:43], v2 offset:41472
    s_mul_i32 s48, s22, 114688
    s_mul_i32 s49, s3, 14336
    s_add_u32 s48, s48, s49
    s_waitcnt lgkmcnt(6)
    v_mfma_f32_32x32x16_bf16 v[88:103], v[60:63], v[12:15], v[88:103]
    ds_read_b64_tr_b16 v[44:45], v3 offset:40960
    ds_read_b64_tr_b16 v[46:47], v3 offset:41472
    s_add_u32 s48, s48, 9441280
    v_lshl_add_u32 v6, v1, 4, s48
    v_add_u32 v7, 8192, v6
    s_waitcnt lgkmcnt(6)
    v_mfma_f32_32x32x16_bf16 v[104:119], v[64:67], v[12:15], v[104:119]
    ds_read_b64_tr_b16 v[48:49], v4 offset:40960
    ds_read_b64_tr_b16 v[50:51], v4 offset:41472
    s_cmp_eq_u32 s43, 1
    s_cbranch_scc0 L_else_120
    s_waitcnt vmcnt(20)
    s_mov_b64 exec, 15
L_chk_122:
    v_cmp_ne_u64 vcc, s[44:45], v[252:253]
    s_cbranch_vccnz L_again_124
L_ok_123:
    s_mov_b64 exec, -1
L_else_120:
    s_waitcnt lgkmcnt(6)
    v_mfma_f32_32x32x16_bf16 v[120:135], v[68:71], v[12:15], v[120:135]
    ds_read_b64_tr_b16 v[52:53], v5 offset:40960
    ds_read_b64_tr_b16 v[54:55], v5 offset:41472
    s_cmp_eq_u32 s43, 1
    s_cbranch_scc0 L_else_125
    global_load_dwordx4 v[12:15], v6, s[38:39] offset:-3072 sc1
    s_branch L_end_126
L_else_125:
    global_load_dwordx4 v[196:199], v248, s[38:39] offset:3072 sc1
L_end_126:
    s_waitcnt vmcnt(22) lgkmcnt(6)
    v_mfma_f32_32x32x16_bf16 v[72:87], v[40:43], v[16:19], v[72:87]
    ds_read_b64_tr_b16 v[56:57], v2 offset:45056
    ds_read_b64_tr_b16 v[58:59], v2 offset:45568
    v_mov_b32 v8, 0
    v_mov_b32 v9, 0
    s_waitcnt lgkmcnt(6)
    v_mfma_f32_32x32x16_bf16 v[88:103], v[44:47], v[16:19], v[88:103]
    ds_read_b64_tr_b16 v[60:61], v3 offset:45056
    ds_read_b64_tr_b16 v[62:63], v3 offset:45568
    v_mov_b32 v10, 0
    v_mov_b32 v11, 0
    s_waitcnt lgkmcnt(6)
    v_mfma_f32_32x32x16_bf16 v[104:119], v[48:51], v[16:19], v[104:119]
    ds_read_b64_tr_b16 v[64:65], v4 offset:45056
    ds_read_b64_tr_b16 v[66:67], v4 offset:45568
    s_waitcnt lgkmcnt(6)
    v_mfma_f32_32x32x16_bf16 v[120:135], v[52:55], v[16:19], v[120:135]
    ds_read_b64_tr_b16 v[68:69], v5 offset:45056
    ds_read_b64_tr_b16 v[70:71], v5 offset:45568
    s_cmp_eq_u32 s43, 1
    s_cbranch_scc0 L_else_127
    global_load_dwordx4 v[16:19], v6, s[38:39] offset:-2048 sc1
    s_branch L_end_128
L_else_127:
    v_add_u32 v248, 8192, v248
    global_load_dwordx4 v[200:203], v248, s[38:39] offset:-4096 sc1
L_end_128:
    s_waitcnt vmcnt(18) lgkmcnt(6)
    v_mfma_f32_32x32x16_bf16 v[72:87], v[56:59], v[20:23], v[72:87]
    ds_read_b64_tr_b16 v[40:41], v2 offset:49152
    ds_read_b64_tr_b16 v[42:43], v2 offset:49664
    s_waitcnt lgkmcnt(6)
    v_mfma_f32_32x32x16_bf16 v[88:103], v[60:63], v[20:23], v[88:103]
    ds_read_b64_tr_b16 v[44:45], v3 offset:49152
    ds_read_b64_tr_b16 v[46:47], v3 offset:49664
    ds_read_b32 v253, v254
    s_waitcnt lgkmcnt(7)
    v_mfma_f32_32x32x16_bf16 v[104:119], v[64:67], v[20:23], v[104:119]
    ds_read_b64_tr_b16 v[48:49], v4 offset:49152
    ds_read_b64_tr_b16 v[50:51], v4 offset:49664
    s_waitcnt lgkmcnt(7)
    v_mfma_f32_32x32x16_bf16 v[120:135], v[68:71], v[20:23], v[120:135]
    ds_read_b64_tr_b16 v[52:53], v5 offset:49152
    ds_read_b64_tr_b16 v[54:55], v5 offset:49664
    s_cmp_eq_u32 s43, 1
    s_cbranch_scc0 L_else_129
    global_load_dwordx4 v[20:23], v6, s[38:39] offset:-1024 sc1
    s_branch L_end_130
L_else_129:
    global_load_dwordx4 v[204:207], v248, s[38:39] offset:-3072 sc1
L_end_130:
    s_waitcnt vmcnt(15) lgkmcnt(7)
    v_mfma_f32_32x32x16_bf16 v[72:87], v[40:43], v[24:27], v[72:87]
    ds_read_b64_tr_b16 v[56:57], v2 offset:53248
    ds_read_b64_tr_b16 v[58:59], v2 offset:53760
    s_waitcnt lgkmcnt(7)
    v_mfma_f32_32x32x16_bf16 v[88:103], v[44:47], v[24:27], v[88:103]
    ds_read_b64_tr_b16 v[60:61], v3 offset:53248
    ds_read_b64_tr_b16 v[62:63], v3 offset:53760
    s_waitcnt lgkmcnt(8)
L_ft_131:
    v_cmp_gt_u32 vcc, 4, v253
    s_cbranch_vccz L_ftok_132
    s_sleep 1
    ds_read_b32 v253, v254
    s_waitcnt lgkmcnt(0)
    s_branch L_ft_131
L_ftok_132:
    s_mov_b32 exec_hi, 0
    ds_read_b64 v[8:9], v255
    s_mov_b32 exec_hi, -1
    s_waitcnt lgkmcnt(7)
    v_mfma_f32_32x32x16_bf16 v[104:119], v[48:51], v[24:27], v[104:119]
    ds_read_b64_tr_b16 v[64:65], v4 offset:53248
    ds_read_b64_tr_b16 v[66:67], v4 offset:53760
    s_waitcnt lgkmcnt(7)
    v_mfma_f32_32x32x16_bf16 v[120:135], v[52:55], v[24:27], v[120:135]
    ds_read_b64_tr_b16 v[68:69], v5 offset:53248
    ds_read_b64_tr_b16 v[70:71], v5 offset:53760
    s_cmp_eq_u32 s43, 1
    s_cbranch_scc0 L_else_133
    global_load_dwordx4 v[24:27], v6, s[38:39] offset:0 sc1
    s_branch L_end_134
L_else_133:
    global_load_dwordx4 v[208:211], v248, s[38:39] offset:-2048 sc1
L_end_134:
    s_waitcnt vmcnt(12) lgkmcnt(7)
    v_mfma_f32_32x32x16_bf16 v[72:87], v[56:59], v[28:31], v[72:87]
    ds_read_b128 v[40:43], v251 offset:0
    s_waitcnt lgkmcnt(6)
    v_mfma_f32_32x32x16_bf16 v[88:103], v[60:63], v[28:31], v[88:103]
    ds_read_b128 v[44:47], v251 offset:512
    s_waitcnt lgkmcnt(4)
    v_mfma_f32_32x32x16_bf16 v[104:119], v[64:67], v[28:31], v[104:119]
    ds_read_b128 v[48:51], v251 offset:1024
    s_waitcnt lgkmcnt(3)
    v_mfma_f32_32x32x16_bf16 v[120:135], v[68:71], v[28:31], v[120:135]
    ds_read_b128 v[52:55], v251 offset:1536
    s_cmp_eq_u32 s43, 1
    s_cbranch_scc0 L_else_135
    global_load_dwordx4 v[28:31], v6, s[38:39] offset:1024 sc1
    s_branch L_end_136
L_else_135:
    global_load_dwordx4 v[212:215], v248, s[38:39] offset:-1024 sc1
L_end_136:
    s_waitcnt lgkmcnt(3)
    v_mfma_f32_32x32x16_bf16 v[72:87], v[40:43], v[8:11], v[72:87]
    ds_read_b64_tr_b16 v[56:57], v2 offset:57344
    ds_read_b64_tr_b16 v[58:59], v2 offset:57856
    ds_read_b64_tr_b16 v[40:41], v2 offset:61440
    ds_read_b64_tr_b16 v[42:43], v2 offset:61952
    s_waitcnt lgkmcnt(6)
    v_mfma_f32_32x32x16_bf16 v[88:103], v[44:47], v[8:11], v[88:103]
    ds_read_b64_tr_b16 v[60:61], v3 offset:57344
    ds_read_b64_tr_b16 v[62:63], v3 offset:57856
    ds_read_b64_tr_b16 v[44:45], v3 offset:61440
    ds_read_b64_tr_b16 v[46:47], v3 offset:61952
    s_waitcnt lgkmcnt(9)
    v_mfma_f32_32x32x16_bf16 v[104:119], v[48:51], v[8:11], v[104:119]
    ds_read_b64_tr_b16 v[64:65], v4 offset:57344
    ds_read_b64_tr_b16 v[66:67], v4 offset:57856
    ds_read_b64_tr_b16 v[48:49], v4 offset:61440
    ds_read_b64_tr_b16 v[50:51], v4 offset:61952
    s_waitcnt lgkmcnt(12)
    v_mfma_f32_32x32x16_bf16 v[120:135], v[52:55], v[8:11], v[120:135]
    ds_read_b64_tr_b16 v[68:69], v5 offset:57344
    ds_read_b64_tr_b16 v[70:71], v5 offset:57856
    ds_read_b64_tr_b16 v[52:53], v5 offset:61440
    ds_read_b64_tr_b16 v[54:55], v5 offset:61952
    s_cmp_eq_u32 s43, 1
    s_cbranch_scc0 L_else_137
    global_load_dwordx4 v[8:11], v6, s[38:39] offset:-4096 sc1
    s_branch L_end_138
L_else_137:
    global_load_dwordx4 v[216:219], v248, s[38:39] offset:0 sc1
L_end_138:
    s_waitcnt vmcnt(10) lgkmcnt(14)
    v_mfma_f32_32x32x16_bf16 v[72:87], v[56:59], v[32:35], v[72:87]
    s_waitcnt vmcnt(6) lgkmcnt(12)
    v_mfma_f32_32x32x16_bf16 v[72:87], v[40:43], v[36:39], v[72:87]
    s_waitcnt lgkmcnt(10)
    v_mfma_f32_32x32x16_bf16 v[88:103], v[60:63], v[32:35], v[88:103]
    s_waitcnt lgkmcnt(8)
    v_mfma_f32_32x32x16_bf16 v[88:103], v[44:47], v[36:39], v[88:103]
    v_mov_b32 v253, 1
    s_waitcnt lgkmcnt(6)
    v_mfma_f32_32x32x16_bf16 v[104:119], v[64:67], v[32:35], v[104:119]
    s_nop 4
    v_mul_f32 v72, v72, v80
    v_mul_f32 v73, v73, v81
    v_mul_f32 v74, v74, v82
    v_mul_f32 v75, v75, v83
    v_mul_f32 v76, v76, v84
    v_mul_f32 v77, v77, v85
    s_waitcnt lgkmcnt(4)
    v_mfma_f32_32x32x16_bf16 v[104:119], v[48:51], v[36:39], v[104:119]
    v_mul_f32 v78, v78, v86
    v_mul_f32 v79, v79, v87
    v_cvt_pk_bf16_f32 v80, v72, v73
    v_cvt_pk_bf16_f32 v81, v74, v75
    v_cvt_pk_bf16_f32 v82, v76, v77
    v_cvt_pk_bf16_f32 v83, v78, v79
    global_store_dwordx4 v249, v[80:83], s[38:39] offset:0 sc1
    s_waitcnt lgkmcnt(2)
    v_mfma_f32_32x32x16_bf16 v[120:135], v[68:71], v[32:35], v[120:135]
    v_mul_f32 v88, v88, v96
    v_mul_f32 v89, v89, v97
    v_mul_f32 v90, v90, v98
    v_mul_f32 v91, v91, v99
    v_mul_f32 v92, v92, v100
    v_mul_f32 v93, v93, v101
    s_waitcnt lgkmcnt(0)
    v_mfma_f32_32x32x16_bf16 v[120:135], v[52:55], v[36:39], v[120:135]
    v_mul_f32 v94, v94, v102
    v_mul_f32 v95, v95, v103
    v_cvt_pk_bf16_f32 v96, v88, v89
    v_cvt_pk_bf16_f32 v97, v90, v91
    v_cvt_pk_bf16_f32 v98, v92, v93
    v_cvt_pk_bf16_f32 v99, v94, v95
    global_store_dwordx4 v249, v[96:99], s[38:39] offset:512 sc1
    s_mov_b64 exec, 1
    ds_add_u32 v254, v253 offset:8
    s_mov_b64 exec, -1
    v_mul_f32 v104, v104, v112
    v_mul_f32 v105, v105, v113
    v_mul_f32 v106, v106, v114
    v_mul_f32 v107, v107, v115
    v_mul_f32 v108, v108, v116
    v_mul_f32 v109, v109, v117
    v_mul_f32 v110, v110, v118
    v_mul_f32 v111, v111, v119
    v_cvt_pk_bf16_f32 v112, v104, v105
    v_cvt_pk_bf16_f32 v113, v106, v107
    v_cvt_pk_bf16_f32 v114, v108, v109
    v_cvt_pk_bf16_f32 v115, v110, v111
    global_store_dwordx4 v249, v[112:115], s[38:39] offset:2048 sc1
    v_mul_f32 v120, v120, v128
    v_mul_f32 v121, v121, v129
    v_mul_f32 v122, v122, v130
    v_mul_f32 v123, v123, v131
    v_mul_f32 v124, v124, v132
    v_mul_f32 v125, v125, v133
    v_mul_f32 v126, v126, v134
    v_mul_f32 v127, v127, v135
    v_cvt_pk_bf16_f32 v128, v120, v121
    v_cvt_pk_bf16_f32 v129, v122, v123
    v_cvt_pk_bf16_f32 v130, v124, v125
    v_cvt_pk_bf16_f32 v131, v126, v127
    global_store_dwordx4 v249, v[128:131], s[38:39] offset:2560 sc1
    s_cmp_eq_u32 s43, 0
    s_cbranch_scc0 L_else_139
    s_xor_b32 s48, s63, 32
    s_lshl_b32 s48, s48, 9
    s_add_u32 s48, s48, 524288
    v_lshl_add_u32 v48, v1, 4, s48
    s_mov_b32 exec_hi, 0
    global_load_dwordx4 v[40:43], v48, s[38:39] sc1
    s_mov_b32 exec_hi, -1
    s_waitcnt vmcnt(1)
    s_lshl_b32 s48, s63, 12
    s_lshl_b32 s49, s61, 7
    s_add_u32 s48, s48, s49
    s_add_u32 s48, s48, 19136512
    v_lshl_add_u32 v68, v1, 4, s48
    v_mov_b32 v64, s44
    v_mov_b32 v65, s45
    v_mov_b32 v66, s44
    v_mov_b32 v67, s45
    s_mov_b64 exec, 255
    global_store_dwordx4 v68, v[64:67], s[38:39] sc1
    s_mov_b64 exec, -1
    s_or_b32 s48, s2, s3
    s_cmp_eq_u32 s48, 0
    s_cbranch_scc0 L_else_141
    v_lshl_add_u32 v56, v1, 4, s48
    v_mov_b32 v52, s44
    v_mov_b32 v53, s45
    v_mov_b32 v54, s44
    v_mov_b32 v55, s45
    s_mov_b64 exec, 1
    global_store_dwordx4 v56, v[52:55], s[38:39] sc1
    s_mov_b64 exec, -1
L_else_141:
    s_mov_b32 exec_hi, 0
    s_waitcnt vmcnt(1)
L_chk_143:
    v_cmp_ne_u64 vcc, s[44:45], v[42:43]
    s_cbranch_vccnz L_again_145
L_ok_144:
    s_mov_b64 exec, -1
    s_lshl_b32 s48, s59, 8
    s_add_u32 s49, s48, 159744
    v_lshl_add_u32 v48, v1, 3, s49
    s_mov_b32 exec_hi, 0
    ds_write_b64 v48, v[40:41]
    s_mov_b32 exec_hi, -1
    v_mov_b32 v62, 161792
    v_mov_b32 v63, 1
    s_mov_b64 exec, 1
    ds_add_u32 v62, v63 offset:68
    s_mov_b64 exec, -1
    global_load_dwordx4 v[220:223], v248, s[38:39] offset:1024 sc1
    global_load_dwordx4 v[224:227], v248, s[38:39] offset:2048 sc1
    global_load_dwordx4 v[228:231], v248, s[38:39] offset:3072 sc1
    v_add_u32 v248, 8192, v248
    global_load_dwordx4 v[232:235], v248, s[38:39] offset:-4096 sc1
    s_waitcnt vmcnt(3)
    global_load_dwordx4 v[236:239], v248, s[38:39] offset:-3072 sc1
    s_waitcnt vmcnt(3)
    global_load_dwordx4 v[240:243], v248, s[38:39] offset:-2048 sc1
    s_waitcnt vmcnt(3)
    global_load_dwordx4 v[244:247], v248, s[38:39] offset:-1024 sc1
    s_mov_b64 exec, 15
    v_mov_b32 v252, 0
    v_mov_b32 v253, 0
    global_atomic_add_x2 v[252:253], v250, v[252:253], s[38:39] sc0 sc1
    s_mov_b64 exec, -1
L_else_139:
    s_branch L_end_114
L_else_113:
    s_lshl_b32 s48, s63, 15
    s_lshl_b32 s49, s59, 13
    s_add_u32 s48, s48, s49
    s_add_u32 s48, s48, 5246976
    v_lshl_add_u32 v69, v1, 4, s48
    global_load_dwordx4 v[72:75], v69, s[38:39] offset:-4096 sc1
    global_load_dwordx4 v[76:79], v69, s[38:39] offset:-3072 sc1
    global_load_dwordx4 v[80:83], v69, s[38:39] offset:-2048 sc1
    global_load_dwordx4 v[84:87], v69, s[38:39] offset:-1024 sc1
    global_load_dwordx4 v[88:91], v69, s[38:39] offset:0 sc1
    global_load_dwordx4 v[92:95], v69, s[38:39] offset:1024 sc1
    global_load_dwordx4 v[96:99], v69, s[38:39] offset:2048 sc1
    global_load_dwordx4 v[100:103], v69, s[38:39] offset:3072 sc1
    v_and_b32 v66, 7, v1
    v_lshrrev_b32 v67, 4, v1
    v_lshl_add_u32 v66, v66, 2, v67
    s_lshl_b32 s48, s3, 8
    s_add_u32 s48, s48, 158720
    v_lshl_add_u32 v66, v66, 3, s48
    v_and_b32 v68, 31, v1
    v_lshl_add_u32 v67, v68, 3, s48
    s_lshl_b32 s48, s63, 9
    s_add_u32 s48, s48, 524288
    v_lshl_add_u32 v69, v68, 4, s48
    s_mov_b32 s48, 1065369472
    s_waitcnt vmcnt(7)
    v_dot2_f32_bf16 v52, v72, s48, 0
    v_dot2_f32_bf16 v56, v72, v72, 0
    v_dot2_f32_bf16 v53, v73, s48, 0
    v_dot2_f32_bf16 v57, v73, v73, 0
    v_dot2_f32_bf16 v54, v74, s48, 0
    v_dot2_f32_bf16 v58, v74, v74, 0
    v_dot2_f32_bf16 v55, v75, s48, 0
    v_dot2_f32_bf16 v59, v75, v75, 0
    s_waitcnt vmcnt(6)
    v_dot2_f32_bf16 v52, v76, s48, v52
    v_dot2_f32_bf16 v56, v76, v76, v56
    v_dot2_f32_bf16 v53, v77, s48, v53
    v_dot2_f32_bf16 v57, v77, v77, v57
    v_dot2_f32_bf16 v54, v78, s48, v54
    v_dot2_f32_bf16 v58, v78, v78, v58
    v_dot2_f32_bf16 v55, v79, s48, v55
    v_dot2_f32_bf16 v59, v79, v79, v59
    s_waitcnt vmcnt(5)
    v_dot2_f32_bf16 v52, v80, s48, v52
    v_dot2_f32_bf16 v56, v80, v80, v56
    v_dot2_f32_bf16 v53, v81, s48, v53
    v_dot2_f32_bf16 v57, v81, v81, v57
    v_dot2_f32_bf16 v54, v82, s48, v54
    v_dot2_f32_bf16 v58, v82, v82, v58
    v_dot2_f32_bf16 v55, v83, s48, v55
    v_dot2_f32_bf16 v59, v83, v83, v59
    s_waitcnt vmcnt(4)
    v_dot2_f32_bf16 v52, v84, s48, v52
    v_dot2_f32_bf16 v56, v84, v84, v56
    v_dot2_f32_bf16 v53, v85, s48, v53
    v_dot2_f32_bf16 v57, v85, v85, v57
    v_dot2_f32_bf16 v54, v86, s48, v54
    v_dot2_f32_bf16 v58, v86, v86, v58
    v_dot2_f32_bf16 v55, v87, s48, v55
    v_dot2_f32_bf16 v59, v87, v87, v59
    s_waitcnt vmcnt(3)
    v_dot2_f32_bf16 v52, v88, s48, v52
    v_dot2_f32_bf16 v56, v88, v88, v56
    v_dot2_f32_bf16 v53, v89, s48, v53
    v_dot2_f32_bf16 v57, v89, v89, v57
    v_dot2_f32_bf16 v54, v90, s48, v54
    v_dot2_f32_bf16 v58, v90, v90, v58
    v_dot2_f32_bf16 v55, v91, s48, v55
    v_dot2_f32_bf16 v59, v91, v91, v59
    s_waitcnt vmcnt(2)
    v_dot2_f32_bf16 v52, v92, s48, v52
    v_dot2_f32_bf16 v56, v92, v92, v56
    v_dot2_f32_bf16 v53, v93, s48, v53
    v_dot2_f32_bf16 v57, v93, v93, v57
    v_dot2_f32_bf16 v54, v94, s48, v54
    v_dot2_f32_bf16 v58, v94, v94, v58
    v_dot2_f32_bf16 v55, v95, s48, v55
    v_dot2_f32_bf16 v59, v95, v95, v59
    s_waitcnt vmcnt(1)
    v_dot2_f32_bf16 v52, v96, s48, v52
    v_dot2_f32_bf16 v56, v96, v96, v56
    v_dot2_f32_bf16 v53, v97, s48, v53
    v_dot2_f32_bf16 v57, v97, v97, v57
    v_dot2_f32_bf16 v54, v98, s48, v54
    v_dot2_f32_bf16 v58, v98, v98, v58
    v_dot2_f32_bf16 v55, v99, s48, v55
    v_dot2_f32_bf16 v59, v99, v99, v59
    s_waitcnt vmcnt(0)
    v_dot2_f32_bf16 v52, v100, s48, v52
    v_dot2_f32_bf16 v56, v100, v100, v56
    v_dot2_f32_bf16 v53, v101, s48, v53
    v_dot2_f32_bf16 v57, v101, v101, v57
    v_dot2_f32_bf16 v54, v102, s48, v54
    v_dot2_f32_bf16 v58, v102, v102, v58
    v_dot2_f32_bf16 v55, v103, s48, v55
    v_dot2_f32_bf16 v59, v103, v103, v59
    v_permlane32_swap_b32 v52, v54
    s_nop 0
    v_permlane32_swap_b32 v53, v55
    v_permlane32_swap_b32 v56, v58
    v_permlane32_swap_b32 v57, v59
    v_add_f32 v52, v52, v54
    v_add_f32 v53, v53, v55
    v_add_f32 v56, v56, v58
    v_add_f32 v57, v57, v59
    v_permlane16_swap_b32 v52, v53
    s_nop 0
    v_permlane16_swap_b32 v56, v57
    v_add_f32 v64, v52, v53
    v_add_f32 v65, v56, v57
    s_nop 0
    v_add_f32_dpp v64, v64, v64 row_ror:8 row_mask:0xf bank_mask:0xf
    v_add_f32_dpp v65, v65, v65 row_ror:8 row_mask:0xf bank_mask:0xf
    ds_write_b64 v66, v[64:65]
    s_cmp_eq_u32 s43, 0
    s_cbranch_scc0 L_else_147
    v_mov_b32 v62, 161792
    v_mov_b32 v63, 1
    s_mov_b64 exec, 1
    ds_add_u32 v62, v63 offset:40
    s_mov_b64 exec, -1
    s_branch L_end_148
L_else_147:
    v_mov_b32 v62, 161792
    v_mov_b32 v63, 1
    s_mov_b64 exec, 1
    ds_add_u32 v62, v63 offset:44
    s_mov_b64 exec, -1
L_end_148:
    s_cmp_eq_u32 s59, 0
    s_cbranch_scc0 L_else_149
    s_cmp_eq_u32 s43, 0
    s_cbranch_scc0 L_else_151
    v_mov_b32 v62, 161792
L_cw_153:
    ds_read_b32 v60, v62 offset:40
    s_waitcnt lgkmcnt(0)
    v_cmp_gt_u32 vcc, 4, v60
    s_cbranch_vccnz L_cw_153
    s_branch L_end_152
L_else_151:
    v_mov_b32 v62, 161792
L_cw_154:
    ds_read_b32 v60, v62 offset:44
    s_waitcnt lgkmcnt(0)
    v_cmp_gt_u32 vcc, 4, v60
    s_cbranch_vccnz L_cw_154
L_end_152:
    ds_read_b64 v[40:41], v67 offset:0
    ds_read_b64 v[42:43], v67 offset:256
    ds_read_b64 v[44:45], v67 offset:512
    ds_read_b64 v[46:47], v67 offset:768
    s_mov_b32 s48, 0x3b000000
    v_mov_b32 v58, s44
    v_mov_b32 v59, s45
    s_waitcnt lgkmcnt(0)
    v_add_f32 v40, v40, v42
    v_add_f32 v41, v41, v43
    v_add_f32 v44, v44, v46
    v_add_f32 v45, v45, v47
    v_add_f32 v40, v40, v44
    v_add_f32 v41, v41, v45
    v_mul_f32 v40, s48, v40
    v_mul_f32 v41, s48, v41
    v_fma_f32 v41, -v40, v40, v41
    v_max_f32 v41, 0, v41
    v_cvt_pk_bf16_f32 v42, v41, v41
    v_lshlrev_b32 v41, 16, v42
    v_add_f32 v41, 0x3727c5ac, v41
    v_cvt_pk_bf16_f32 v42, v41, v41
    v_lshlrev_b32 v41, 16, v42
    v_sqrt_f32 v41, v41
    v_cvt_pk_bf16_f32 v56, -v40, -v40
    v_cvt_pk_bf16_f32 v57, v41, v41
    s_mov_b32 exec_hi, 0
    global_store_dwordx4 v69, v[56:59], s[38:39] sc1
    s_mov_b32 exec_hi, -1
L_else_149:
    s_cmp_eq_u32 s43, 0
    s_cbranch_scc0 L_else_155
    v_mov_b32 v62, 161792
    v_mov_b32 v63, 1
    s_mov_b64 exec, 1
    ds_add_u32 v62, v63 offset:72
    s_mov_b64 exec, -1
    s_branch L_end_156
L_else_155:
    v_mov_b32 v62, 161792
    v_mov_b32 v63, 1
    s_mov_b64 exec, 1
    ds_add_u32 v62, v63 offset:76
    s_mov_b64 exec, -1
L_end_156:
    s_waitcnt lgkmcnt(0)
    s_barrier
    s_lshl_b32 s48, s22, 12
    s_lshl_b32 s49, s62, 7
    s_add_u32 s48, s48, s49
    s_add_u32 s48, s48, 19136512
    v_and_b32 v250, 3, v1
    v_lshl_add_u32 v250, v250, 7, s48
    s_mul_i32 s48, s22, 114688
    s_mul_i32 s49, s3, 14336
    s_add_u32 s48, s48, s49
    s_add_u32 s48, s48, 9441280
    v_lshl_add_u32 v6, v1, 4, s48
    v_add_u32 v7, 8192, v6
    s_cmp_eq_u32 s43, 0
    s_cbranch_scc0 L_else_157
    s_mov_b64 exec, 15
    v_mov_b32 v254, 0
    v_mov_b32 v255, 0
    global_atomic_add_x2 v[254:255], v251, v[254:255], s[38:39] sc0 sc1
    s_mov_b64 exec, -1
    s_waitcnt vmcnt(0)
    s_mov_b64 exec, 15
L_chk_159:
    v_cmp_ne_u64 vcc, s[44:45], v[254:255]
    s_cbranch_vccnz L_again_161
L_ok_160:
    s_mov_b64 exec, -1
    global_load_dwordx4 v[136:139], v248, s[38:39] offset:-4096 sc1
    global_load_dwordx4 v[140:143], v248, s[38:39] offset:-3072 sc1
    global_load_dwordx4 v[144:147], v248, s[38:39] offset:-2048 sc1
    global_load_dwordx4 v[148:151], v248, s[38:39] offset:-1024 sc1
    global_load_dwordx4 v[152:155], v248, s[38:39] offset:0 sc1
    global_load_dwordx4 v[156:159], v248, s[38:39] offset:1024 sc1
    global_load_dwordx4 v[160:163], v248, s[38:39] offset:2048 sc1
    global_load_dwordx4 v[164:167], v248, s[38:39] offset:3072 sc1
    v_add_u32 v248, 8192, v248
    global_load_dwordx4 v[168:171], v248, s[38:39] offset:-4096 sc1
    global_load_dwordx4 v[172:175], v248, s[38:39] offset:-3072 sc1
    global_load_dwordx4 v[176:179], v248, s[38:39] offset:-2048 sc1
    global_load_dwordx4 v[180:183], v248, s[38:39] offset:-1024 sc1
    global_load_dwordx4 v[184:187], v248, s[38:39] offset:0 sc1
    global_load_dwordx4 v[188:191], v248, s[38:39] offset:1024 sc1
    global_load_dwordx4 v[192:195], v248, s[38:39] offset:2048 sc1
    global_load_dwordx4 v[196:199], v248, s[38:39] offset:3072 sc1
    v_add_u32 v248, 8192, v248
    global_load_dwordx4 v[200:203], v248, s[38:39] offset:-4096 sc1
    global_load_dwordx4 v[204:207], v248, s[38:39] offset:-3072 sc1
L_else_157:
    global_load_dwordx4 v[208:211], v248, s[38:39] offset:-2048 sc1
    global_load_dwordx4 v[212:215], v248, s[38:39] offset:-1024 sc1
    global_load_dwordx4 v[216:219], v248, s[38:39] offset:0 sc1
    global_load_dwordx4 v[220:223], v248, s[38:39] offset:1024 sc1
    global_load_dwordx4 v[224:227], v248, s[38:39] offset:2048 sc1
    global_load_dwordx4 v[228:231], v248, s[38:39] offset:3072 sc1
    v_add_u32 v248, 8192, v248
    global_load_dwordx4 v[232:235], v248, s[38:39] offset:-4096 sc1
    global_load_dwordx4 v[236:239], v248, s[38:39] offset:-3072 sc1
    global_load_dwordx4 v[240:243], v248, s[38:39] offset:-2048 sc1
    global_load_dwordx4 v[244:247], v248, s[38:39] offset:-1024 sc1
    s_waitcnt vmcnt(0)
    s_barrier
    s_cmp_eq_u32 s43, 1
    s_cbranch_scc0 L_else_162
    s_mov_b64 exec, 15
    v_mov_b32 v252, 0
    v_mov_b32 v253, 0
    global_atomic_add_x2 v[252:253], v250, v[252:253], s[38:39] sc0 sc1
    s_mov_b64 exec, -1
    s_waitcnt vmcnt(0)
    s_mov_b64 exec, 15
L_chk_164:
    v_cmp_ne_u64 vcc, s[44:45], v[252:253]
    s_cbranch_vccnz L_again_166
L_ok_165:
    s_mov_b64 exec, -1
    global_load_dwordx4 v[12:15], v6, s[38:39] offset:-3072 sc1
    global_load_dwordx4 v[16:19], v6, s[38:39] offset:-2048 sc1
    global_load_dwordx4 v[20:23], v6, s[38:39] offset:-1024 sc1
    global_load_dwordx4 v[24:27], v6, s[38:39] offset:0 sc1
    global_load_dwordx4 v[28:31], v6, s[38:39] offset:1024 sc1
    global_load_dwordx4 v[8:11], v6, s[38:39] offset:-4096 sc1
    s_waitcnt vmcnt(0)
L_else_162:
L_end_114:
    s_lshl_b32 s48, s22, 15
    s_lshl_b32 s49, s23, 12
    s_add_u32 s48, s48, s49
    s_add_u32 s48, s48, 5242880
    v_and_b32 v5, 255, v0
    v_lshl_add_u32 v5, v5, 4, s48
    v_bfe_u32 v3, v0, 3, 2
    s_lshl_b32 s48, s43, 4
    s_add_u32 s48, s48, s59
    v_lshl_add_u32 v3, v3, 2, s48
    v_lshlrev_b32 v4, 3, v0
    s_lshl_b32 s48, s22, 9
    s_add_u32 s48, s48, 524292
    v_lshl_add_u32 v2, v3, 4, s48
    s_cmp_eq_u32 s43, 0
    s_cbranch_scc0 L_else_167
    s_cmp_lt_u32 s2, 224
    s_cbranch_scc0 L_else_169
    s_waitcnt vmcnt(0)
    s_mov_b64 exec, 15
L_chk_171:
    v_cmp_ne_u64 vcc, s[44:45], v[252:253]
    s_cbranch_vccnz L_again_173
L_ok_172:
    s_mov_b64 exec, -1
    s_branch L_end_170
L_else_169:
    s_mov_b64 exec, 15
    v_mov_b32 v252, 0
    v_mov_b32 v253, 0
    global_atomic_add_x2 v[252:253], v250, v[252:253], s[38:39] sc0 sc1
    s_mov_b64 exec, -1
    s_waitcnt vmcnt(0)
    s_mov_b64 exec, 15
L_chk_174:
    v_cmp_ne_u64 vcc, s[44:45], v[252:253]
    s_cbranch_vccnz L_again_176
L_ok_175:
    s_mov_b64 exec, -1
L_end_170:
    global_load_dwordx4 v[8:11], v6, s[38:39] offset:-4096 sc1
    global_load_dwordx4 v[12:15], v6, s[38:39] offset:-3072 sc1
    global_load_dwordx4 v[16:19], v6, s[38:39] offset:-2048 sc1
    global_load_dwordx4 v[20:23], v6, s[38:39] offset:-1024 sc1
    s_waitcnt vmcnt(3)
    global_load_dwordx4 v[24:27], v6, s[38:39] offset:0 sc1
    s_waitcnt vmcnt(3)
    global_load_dwordx4 v[28:31], v6, s[38:39] offset:1024 sc1
    s_waitcnt vmcnt(3)
    global_load_dwordx4 v[32:35], v6, s[38:39] offset:2048 sc1
    s_waitcnt vmcnt(3)
    global_load_dwordx4 v[36:39], v6, s[38:39] offset:3072 sc1
    s_waitcnt vmcnt(3)
    global_load_dwordx4 v[40:43], v7, s[38:39] offset:-4096 sc1
    s_waitcnt vmcnt(3)
    global_load_dwordx4 v[44:47], v7, s[38:39] offset:-3072 sc1
    s_waitcnt vmcnt(3)
    global_load_dwordx4 v[48:51], v7, s[38:39] offset:-2048 sc1
    s_waitcnt vmcnt(3)
    global_load_dwordx4 v[52:55], v7, s[38:39] offset:-1024 sc1
    s_waitcnt vmcnt(3)
    global_load_dwordx4 v[56:59], v7, s[38:39] offset:0 sc1
    s_waitcnt vmcnt(3)
    global_load_dwordx4 v[60:63], v7, s[38:39] offset:1024 sc1
    global_load_dword v70, v2, s[38:39] sc1
    global_load_dwordx4 v[64:67], v5, s[38:39] sc1
    v_add_u32 v250, 131072, v250
    v_add_u32 v2, 16384, v2
    v_add_u32 v6, 3670016, v6
    v_add_u32 v7, 3670016, v7
    v_add_u32 v5, 1048576, v5
    v_lshrrev_b32 v248, 5, v1
    v_and_b32 v255, 7, v1
    v_lshl_add_u32 v255, v248, 3, v255
    v_mul_u32_u24 v248, 288, v255
    v_lshl_add_u32 v248, v3, 2, v248
    v_add_u32 v248, 131072, v248
    v_lshlrev_b32 v249, 4, v255
    v_add_u32 v249, 163584, v249
    s_lshl_b32 s48, s22, 15
    s_lshl_b32 s49, s23, 7
    s_add_u32 s48, s48, s49
    v_lshlrev_b32 v251, 10, v3
    v_lshl_add_u32 v251, v255, 3, v251
    v_add_u32 v251, s48, v251
    s_setprio 0
    v_mfma_f32_16x16x32_bf16 v[104:107], v[8:11], v[136:139], 0
    v_mfma_f32_16x16x32_bf16 v[108:111], v[8:11], v[140:143], 0
    v_mfma_f32_16x16x32_bf16 v[112:115], v[8:11], v[144:147], 0
    v_mfma_f32_16x16x32_bf16 v[116:119], v[8:11], v[148:151], 0
    v_mfma_f32_16x16x32_bf16 v[120:123], v[12:15], v[136:139], 0
    v_mfma_f32_16x16x32_bf16 v[124:127], v[12:15], v[140:143], 0
    v_mfma_f32_16x16x32_bf16 v[128:131], v[12:15], v[144:147], 0
    v_mfma_f32_16x16x32_bf16 v[132:135], v[12:15], v[148:151], 0
    v_mfma_f32_16x16x32_bf16 v[104:107], v[16:19], v[152:155], v[104:107]
    v_mfma_f32_16x16x32_bf16 v[108:111], v[16:19], v[156:159], v[108:111]
    v_mfma_f32_16x16x32_bf16 v[112:115], v[16:19], v[160:163], v[112:115]
    v_mfma_f32_16x16x32_bf16 v[116:119], v[16:19], v[164:167], v[116:119]
    v_mfma_f32_16x16x32_bf16 v[120:123], v[20:23], v[152:155], v[120:123]
    v_mfma_f32_16x16x32_bf16 v[124:127], v[20:23], v[156:159], v[124:127]
    v_mfma_f32_16x16x32_bf16 v[128:131], v[20:23], v[160:163], v[128:131]
    v_mfma_f32_16x16x32_bf16 v[132:135], v[20:23], v[164:167], v[132:135]
    v_mfma_f32_16x16x32_bf16 v[104:107], v[24:27], v[168:171], v[104:107]
    v_mfma_f32_16x16x32_bf16 v[108:111], v[24:27], v[172:175], v[108:111]
    v_mfma_f32_16x16x32_bf16 v[112:115], v[24:27], v[176:179], v[112:115]
    v_mfma_f32_16x16x32_bf16 v[116:119], v[24:27], v[180:183], v[116:119]
    v_mfma_f32_16x16x32_bf16 v[120:123], v[28:31], v[168:171], v[120:123]
    v_mfma_f32_16x16x32_bf16 v[124:127], v[28:31], v[172:175], v[124:127]
    v_mfma_f32_16x16x32_bf16 v[128:131], v[28:31], v[176:179], v[128:131]
    v_mfma_f32_16x16x32_bf16 v[132:135], v[28:31], v[180:183], v[132:135]
    v_mfma_f32_16x16x32_bf16 v[104:107], v[32:35], v[184:187], v[104:107]
    v_mfma_f32_16x16x32_bf16 v[108:111], v[32:35], v[188:191], v[108:111]
    v_mfma_f32_16x16x32_bf16 v[112:115], v[32:35], v[192:195], v[112:115]
    v_mfma_f32_16x16x32_bf16 v[116:119], v[32:35], v[196:199], v[116:119]
    v_mfma_f32_16x16x32_bf16 v[120:123], v[36:39], v[184:187], v[120:123]
    v_mfma_f32_16x16x32_bf16 v[124:127], v[36:39], v[188:191], v[124:127]
    v_mfma_f32_16x16x32_bf16 v[128:131], v[36:39], v[192:195], v[128:131]
    v_mfma_f32_16x16x32_bf16 v[132:135], v[36:39], v[196:199], v[132:135]
    v_mfma_f32_16x16x32_bf16 v[104:107], v[40:43], v[200:203], v[104:107]
    v_mfma_f32_16x16x32_bf16 v[108:111], v[40:43], v[204:207], v[108:111]
    v_mfma_f32_16x16x32_bf16 v[112:115], v[40:43], v[208:211], v[112:115]
    v_mfma_f32_16x16x32_bf16 v[116:119], v[40:43], v[212:215], v[116:119]
    v_mfma_f32_16x16x32_bf16 v[120:123], v[44:47], v[200:203], v[120:123]
    v_mfma_f32_16x16x32_bf16 v[124:127], v[44:47], v[204:207], v[124:127]
    v_mfma_f32_16x16x32_bf16 v[128:131], v[44:47], v[208:211], v[128:131]
    v_mfma_f32_16x16x32_bf16 v[132:135], v[44:47], v[212:215], v[132:135]
    s_waitcnt vmcnt(5)
    v_mfma_f32_16x16x32_bf16 v[104:107], v[48:51], v[216:219], v[104:107]
    v_mfma_f32_16x16x32_bf16 v[108:111], v[48:51], v[220:223], v[108:111]
    v_mfma_f32_16x16x32_bf16 v[112:115], v[48:51], v[224:227], v[112:115]
    v_mfma_f32_16x16x32_bf16 v[116:119], v[48:51], v[228:231], v[116:119]
    s_waitcnt vmcnt(4)
    v_mfma_f32_16x16x32_bf16 v[120:123], v[52:55], v[216:219], v[120:123]
    v_mfma_f32_16x16x32_bf16 v[124:127], v[52:55], v[220:223], v[124:127]
    v_mfma_f32_16x16x32_bf16 v[128:131], v[52:55], v[224:227], v[128:131]
    v_mfma_f32_16x16x32_bf16 v[132:135], v[52:55], v[228:231], v[132:135]
    s_waitcnt vmcnt(3)
    v_mfma_f32_16x16x32_bf16 v[104:107], v[56:59], v[232:235], v[104:107]
    v_mfma_f32_16x16x32_bf16 v[108:111], v[56:59], v[236:239], v[108:111]
    v_mfma_f32_16x16x32_bf16 v[112:115], v[56:59], v[240:243], v[112:115]
    v_mfma_f32_16x16x32_bf16 v[116:119], v[56:59], v[244:247], v[116:119]
    s_waitcnt vmcnt(2)
    v_mfma_f32_16x16x32_bf16 v[120:123], v[60:63], v[232:235], v[120:123]
    v_mfma_f32_16x16x32_bf16 v[124:127], v[60:63], v[236:239], v[124:127]
    v_mfma_f32_16x16x32_bf16 v[128:131], v[60:63], v[240:243], v[128:131]
    v_mfma_f32_16x16x32_bf16 v[132:135], v[60:63], v[244:247], v[132:135]
    v_bfe_u32 v68, v0, 3, 5
    v_mul_u32_u24 v68, 144, v68
    v_and_b32 v255, 7, v1
    v_lshl_add_u32 v68, v255, 4, v68
    v_add_u32 v68, 131072, v68
    s_waitcnt vmcnt(0)
    ds_write_b128 v68, v[64:67]
    v_mov_b32 v62, 161792
L_cw_178:
    ds_read2_b32 v[60:61], v62 offset0:18 offset1:19
    s_waitcnt lgkmcnt(0)
    v_min_u32 v60, v60, v61
    v_cmp_gt_u32 vcc, 4, v60
    s_cbranch_vccz L_cok_179
    s_sleep 1
    s_branch L_cw_178
L_cok_179:
    s_setprio 2
    s_mov_b64 exec, 15
    v_mov_b32 v252, 0
    v_mov_b32 v253, 0
    global_atomic_add_x2 v[252:253], v250, v[252:253], s[38:39] sc0 sc1
    s_mov_b64 exec, -1
    s_lshl_b32 s48, s3, 13
    s_add_u32 m0, s48, 0
    s_nop 0
    ds_write_addtid_b32 v104 offset:0
    ds_write_addtid_b32 v105 offset:512
    ds_write_addtid_b32 v106 offset:1024
    ds_write_addtid_b32 v107 offset:1536
    ds_write_addtid_b32 v108 offset:4096
    ds_write_addtid_b32 v109 offset:4608
    ds_write_addtid_b32 v110 offset:5120
    ds_write_addtid_b32 v111 offset:5632
    ds_write_addtid_b32 v112 offset:256
    ds_write_addtid_b32 v113 offset:768
    ds_write_addtid_b32 v114 offset:1280
    ds_write_addtid_b32 v115 offset:1792
    ds_write_addtid_b32 v116 offset:4352
    ds_write_addtid_b32 v117 offset:4864
    ds_write_addtid_b32 v118 offset:5376
    ds_write_addtid_b32 v119 offset:5888
    ds_write_addtid_b32 v120 offset:2048
    ds_write_addtid_b32 v121 offset:2560
    ds_write_addtid_b32 v122 offset:3072
    ds_write_addtid_b32 v123 offset:3584
    ds_write_addtid_b32 v124 offset:6144
    ds_write_addtid_b32 v125 offset:6656
    ds_write_addtid_b32 v126 offset:7168
    ds_write_addtid_b32 v127 offset:7680
    ds_write_addtid_b32 v128 offset:2304
    ds_write_addtid_b32 v129 offset:2816
    ds_write_addtid_b32 v130 offset:3328
    ds_write_addtid_b32 v131 offset:3840
    ds_write_addtid_b32 v132 offset:6400
    ds_write_addtid_b32 v133 offset:6912
    ds_write_addtid_b32 v134 offset:7424
    ds_write_addtid_b32 v135 offset:7936
    v_mov_b32 v62, 161792
    v_mov_b32 v63, 1
    s_mov_b64 exec, 1
    ds_add_u32 v62, v63 offset:56
    s_mov_b64 exec, -1
    s_waitcnt vmcnt(0)
    s_mov_b64 exec, 15
L_chk_180:
    v_cmp_ne_u64 vcc, s[44:45], v[252:253]
    s_cbranch_vccnz L_again_182
L_ok_181:
    s_mov_b64 exec, -1
    global_load_dwordx4 v[8:11], v6, s[38:39] offset:-4096 sc1
    global_load_dwordx4 v[12:15], v6, s[38:39] offset:-3072 sc1
    global_load_dwordx4 v[16:19], v6, s[38:39] offset:-2048 sc1
    global_load_dwordx4 v[20:23], v6, s[38:39] offset:-1024 sc1
    global_load_dwordx4 v[24:27], v6, s[38:39] offset:0 sc1
    s_waitcnt vmcnt(4)
    v_mfma_f32_16x16x32_bf16 v[104:107], v[8:11], v[136:139], 0
    v_mfma_f32_16x16x32_bf16 v[108:111], v[8:11], v[140:143], 0
    v_mfma_f32_16x16x32_bf16 v[112:115], v[8:11], v[144:147], 0
    v_mfma_f32_16x16x32_bf16 v[116:119], v[8:11], v[148:151], 0
    global_load_dwordx4 v[28:31], v6, s[38:39] offset:1024 sc1
    s_waitcnt vmcnt(4)
    v_mfma_f32_16x16x32_bf16 v[120:123], v[12:15], v[136:139], 0
    v_mfma_f32_16x16x32_bf16 v[124:127], v[12:15], v[140:143], 0
    v_mfma_f32_16x16x32_bf16 v[128:131], v[12:15], v[144:147], 0
    v_mfma_f32_16x16x32_bf16 v[132:135], v[12:15], v[148:151], 0
    global_load_dwordx4 v[32:35], v6, s[38:39] offset:2048 sc1
    s_waitcnt vmcnt(4)
    v_mfma_f32_16x16x32_bf16 v[104:107], v[16:19], v[152:155], v[104:107]
    v_mfma_f32_16x16x32_bf16 v[108:111], v[16:19], v[156:159], v[108:111]
    v_mfma_f32_16x16x32_bf16 v[112:115], v[16:19], v[160:163], v[112:115]
    v_mfma_f32_16x16x32_bf16 v[116:119], v[16:19], v[164:167], v[116:119]
    global_load_dwordx4 v[36:39], v6, s[38:39] offset:3072 sc1
    s_waitcnt vmcnt(4)
    v_mfma_f32_16x16x32_bf16 v[120:123], v[20:23], v[152:155], v[120:123]
    v_mfma_f32_16x16x32_bf16 v[124:127], v[20:23], v[156:159], v[124:127]
    v_mfma_f32_16x16x32_bf16 v[128:131], v[20:23], v[160:163], v[128:131]
    v_mfma_f32_16x16x32_bf16 v[132:135], v[20:23], v[164:167], v[132:135]
    global_load_dwordx4 v[40:43], v7, s[38:39] offset:-4096 sc1
    s_waitcnt vmcnt(4)
    v_mfma_f32_16x16x32_bf16 v[104:107], v[24:27], v[168:171], v[104:107]
    v_mfma_f32_16x16x32_bf16 v[108:111], v[24:27], v[172:175], v[108:111]
    v_mfma_f32_16x16x32_bf16 v[112:115], v[24:27], v[176:179], v[112:115]
    v_mfma_f32_16x16x32_bf16 v[116:119], v[24:27], v[180:183], v[116:119]
    global_load_dwordx4 v[44:47], v7, s[38:39] offset:-3072 sc1
    s_waitcnt vmcnt(4)
    v_mfma_f32_16x16x32_bf16 v[120:123], v[28:31], v[168:171], v[120:123]
    v_mfma_f32_16x16x32_bf16 v[124:127], v[28:31], v[172:175], v[124:127]
    v_mfma_f32_16x16x32_bf16 v[128:131], v[28:31], v[176:179], v[128:131]
    v_mfma_f32_16x16x32_bf16 v[132:135], v[28:31], v[180:183], v[132:135]
    global_load_dwordx4 v[48:51], v7, s[38:39] offset:-2048 sc1
    s_waitcnt vmcnt(4)
    v_mfma_f32_16x16x32_bf16 v[104:107], v[32:35], v[184:187], v[104:107]
    v_mfma_f32_16x16x32_bf16 v[108:111], v[32:35], v[188:191], v[108:111]
    v_mfma_f32_16x16x32_bf16 v[112:115], v[32:35], v[192:195], v[112:115]
    v_mfma_f32_16x16x32_bf16 v[116:119], v[32:35], v[196:199], v[116:119]
    global_load_dwordx4 v[52:55], v7, s[38:39] offset:-1024 sc1
    s_waitcnt vmcnt(4)
    v_mfma_f32_16x16x32_bf16 v[120:123], v[36:39], v[184:187], v[120:123]
    v_mfma_f32_16x16x32_bf16 v[124:127], v[36:39], v[188:191], v[124:127]
    v_mfma_f32_16x16x32_bf16 v[128:131], v[36:39], v[192:195], v[128:131]
    v_mfma_f32_16x16x32_bf16 v[132:135], v[36:39], v[196:199], v[132:135]
    global_load_dwordx4 v[56:59], v7, s[38:39] offset:0 sc1
    s_waitcnt vmcnt(4)
    v_mfma_f32_16x16x32_bf16 v[104:107], v[40:43], v[200:203], v[104:107]
    v_mfma_f32_16x16x32_bf16 v[108:111], v[40:43], v[204:207], v[108:111]
    v_mfma_f32_16x16x32_bf16 v[112:115], v[40:43], v[208:211], v[112:115]
    v_mfma_f32_16x16x32_bf16 v[116:119], v[40:43], v[212:215], v[116:119]
    global_load_dwordx4 v[60:63], v7, s[38:39] offset:1024 sc1
    s_waitcnt vmcnt(4)
    v_mfma_f32_16x16x32_bf16 v[120:123], v[44:47], v[200:203], v[120:123]
    v_mfma_f32_16x16x32_bf16 v[124:127], v[44:47], v[204:207], v[124:127]
    v_mfma_f32_16x16x32_bf16 v[128:131], v[44:47], v[208:211], v[128:131]
    v_mfma_f32_16x16x32_bf16 v[132:135], v[44:47], v[212:215], v[132:135]
    v_mov_b32 v22, 161792
L_cw_184:
    ds_read2_b32 v[20:21], v22 offset0:14 offset1:15
    s_waitcnt lgkmcnt(0)
    v_min_u32 v20, v20, v21
    v_cmp_gt_u32 vcc, 4, v20
    s_cbranch_vccz L_cok_185
    s_sleep 1
    s_branch L_cw_184
L_cok_185:
    ds_read_b128 v[8:11], v249
    v_lshlrev_b32 v254, 16, v70
    v_rcp_f32 v254, v254
    s_nop 0
    v_mul_f32 v254, v254, v254
    s_waitcnt lgkmcnt(0)
    v_mul_f32 v8, v254, v8
    v_mul_f32 v9, v254, v9
    v_mul_f32 v10, v254, v10
    v_mul_f32 v11, v254, v11
    ds_read2_b32 v[12:13], v248 offset0:0 offset1:36
    ds_read_b64 v[72:73], v4 offset:0
    ds_read_b64 v[74:75], v4 offset:4096
    ds_read_b64 v[76:77], v4 offset:8192
    ds_read_b64 v[78:79], v4 offset:12288
    ds_read_b64 v[80:81], v4 offset:16384
    ds_read_b64 v[82:83], v4 offset:20480
    ds_read_b64 v[84:85], v4 offset:24576
    ds_read_b64 v[86:87], v4 offset:28672
    ds_read_b64 v[88:89], v4 offset:32768
    ds_read_b64 v[90:91], v4 offset:36864
    ds_read_b64 v[92:93], v4 offset:40960
    ds_read_b64 v[94:95], v4 offset:45056
    ds_read_b64 v[96:97], v4 offset:49152
    ds_read_b64 v[98:99], v4 offset:53248
    ds_read_b64 v[100:101], v4 offset:57344
    ds_read_b64 v[102:103], v4 offset:61440
    s_waitcnt lgkmcnt(15)
    v_lshlrev_b32 v16, 16, v12
    v_and_b32 v17, 0xffff0000, v12
    v_lshlrev_b32 v18, 16, v13
    v_and_b32 v19, 0xffff0000, v13
    s_waitcnt lgkmcnt(12)
    v_add_f32 v72, v72, v76
    v_add_f32 v73, v73, v77
    v_add_f32 v74, v74, v78
    v_add_f32 v75, v75, v79
    s_waitcnt lgkmcnt(10)
    v_add_f32 v72, v72, v80
    v_add_f32 v73, v73, v81
    v_add_f32 v74, v74, v82
    v_add_f32 v75, v75, v83
    s_waitcnt lgkmcnt(8)
    v_add_f32 v72, v72, v84
    v_add_f32 v73, v73, v85
    v_add_f32 v74, v74, v86
    v_add_f32 v75, v75, v87
    s_waitcnt lgkmcnt(6)
    v_add_f32 v72, v72, v88
    v_add_f32 v73, v73, v89
    v_add_f32 v74, v74, v90
    v_add_f32 v75, v75, v91
    s_waitcnt lgkmcnt(4)
    v_add_f32 v72, v72, v92
    v_add_f32 v73, v73, v93
    v_add_f32 v74, v74, v94
    v_add_f32 v75, v75, v95
    s_waitcnt lgkmcnt(2)
    v_add_f32 v72, v72, v96
    v_add_f32 v73, v73, v97
    v_add_f32 v74, v74, v98
    v_add_f32 v75, v75, v99
    s_waitcnt lgkmcnt(0)
    v_add_f32 v72, v72, v100
    v_add_f32 v73, v73, v101
    v_add_f32 v74, v74, v102
    v_add_f32 v75, v75, v103
    v_fmac_f32 v16, v8, v72
    v_fmac_f32 v17, v9, v74
    v_fmac_f32 v18, v10, v73
    v_fmac_f32 v19, v11, v75
    v_cvt_pk_bf16_f32 v14, v16, v17
    v_cvt_pk_bf16_f32 v15, v18, v19
    global_store_dwordx2 v251, v[14:15], s[34:35]
    global_load_dword v71, v2, s[38:39] sc1
    global_load_dwordx4 v[64:67], v5, s[38:39] sc1
    s_waitcnt vmcnt(6)
    v_mfma_f32_16x16x32_bf16 v[104:107], v[48:51], v[216:219], v[104:107]
    v_mfma_f32_16x16x32_bf16 v[108:111], v[48:51], v[220:223], v[108:111]
    v_mfma_f32_16x16x32_bf16 v[112:115], v[48:51], v[224:227], v[112:115]
    v_mfma_f32_16x16x32_bf16 v[116:119], v[48:51], v[228:231], v[116:119]
    s_waitcnt vmcnt(5)
    v_mfma_f32_16x16x32_bf16 v[120:123], v[52:55], v[216:219], v[120:123]
    v_mfma_f32_16x16x32_bf16 v[124:127], v[52:55], v[220:223], v[124:127]
    v_mfma_f32_16x16x32_bf16 v[128:131], v[52:55], v[224:227], v[128:131]
    v_mfma_f32_16x16x32_bf16 v[132:135], v[52:55], v[228:231], v[132:135]
    s_waitcnt vmcnt(4)
    v_mfma_f32_16x16x32_bf16 v[104:107], v[56:59], v[232:235], v[104:107]
    v_mfma_f32_16x16x32_bf16 v[108:111], v[56:59], v[236:239], v[108:111]
    v_mfma_f32_16x16x32_bf16 v[112:115], v[56:59], v[240:243], v[112:115]
    v_mfma_f32_16x16x32_bf16 v[116:119], v[56:59], v[244:247], v[116:119]
    s_waitcnt vmcnt(3)
    v_mfma_f32_16x16x32_bf16 v[120:123], v[60:63], v[232:235], v[120:123]
    v_mfma_f32_16x16x32_bf16 v[124:127], v[60:63], v[236:239], v[124:127]
    v_mfma_f32_16x16x32_bf16 v[128:131], v[60:63], v[240:243], v[128:131]
    v_mfma_f32_16x16x32_bf16 v[132:135], v[60:63], v[244:247], v[132:135]
    v_bfe_u32 v68, v0, 3, 5
    v_mul_u32_u24 v68, 144, v68
    v_and_b32 v255, 7, v1
    v_lshl_add_u32 v68, v255, 4, v68
    v_add_u32 v68, 135680, v68
    s_waitcnt vmcnt(0)
    ds_write_b128 v68, v[64:67]
    s_lshl_b32 s48, s3, 13
    s_add_u32 m0, s48, 65536
    s_nop 0
    ds_write_addtid_b32 v104 offset:0
    ds_write_addtid_b32 v105 offset:512
    ds_write_addtid_b32 v106 offset:1024
    ds_write_addtid_b32 v107 offset:1536
    ds_write_addtid_b32 v108 offset:4096
    ds_write_addtid_b32 v109 offset:4608
    ds_write_addtid_b32 v110 offset:5120
    ds_write_addtid_b32 v111 offset:5632
    ds_write_addtid_b32 v112 offset:256
    ds_write_addtid_b32 v113 offset:768
    ds_write_addtid_b32 v114 offset:1280
    ds_write_addtid_b32 v115 offset:1792
    ds_write_addtid_b32 v116 offset:4352
    ds_write_addtid_b32 v117 offset:4864
    ds_write_addtid_b32 v118 offset:5376
    ds_write_addtid_b32 v119 offset:5888
    ds_write_addtid_b32 v120 offset:2048
    ds_write_addtid_b32 v121 offset:2560
    ds_write_addtid_b32 v122 offset:3072
    ds_write_addtid_b32 v123 offset:3584
    ds_write_addtid_b32 v124 offset:6144
    ds_write_addtid_b32 v125 offset:6656
    ds_write_addtid_b32 v126 offset:7168
    ds_write_addtid_b32 v127 offset:7680
    ds_write_addtid_b32 v128 offset:2304
    ds_write_addtid_b32 v129 offset:2816
    ds_write_addtid_b32 v130 offset:3328
    ds_write_addtid_b32 v131 offset:3840
    ds_write_addtid_b32 v132 offset:6400
    ds_write_addtid_b32 v133 offset:6912
    ds_write_addtid_b32 v134 offset:7424
    ds_write_addtid_b32 v135 offset:7936
    s_branch L_end_168
L_else_167:
    s_waitcnt vmcnt(9)
    v_mfma_f32_16x16x32_bf16 v[120:123], v[12:15], v[136:139], 0
    v_mfma_f32_16x16x32_bf16 v[124:127], v[12:15], v[140:143], 0
    v_mfma_f32_16x16x32_bf16 v[128:131], v[12:15], v[144:147], 0
    v_mfma_f32_16x16x32_bf16 v[132:135], v[12:15], v[148:151], 0
    s_waitcnt vmcnt(8)
    v_mfma_f32_16x16x32_bf16 v[104:107], v[16:19], v[152:155], 0
    v_mfma_f32_16x16x32_bf16 v[108:111], v[16:19], v[156:159], 0
    v_mfma_f32_16x16x32_bf16 v[112:115], v[16:19], v[160:163], 0
    v_mfma_f32_16x16x32_bf16 v[116:119], v[16:19], v[164:167], 0
    s_waitcnt vmcnt(7)
    v_mfma_f32_16x16x32_bf16 v[120:123], v[20:23], v[152:155], v[120:123]
    v_mfma_f32_16x16x32_bf16 v[124:127], v[20:23], v[156:159], v[124:127]
    v_mfma_f32_16x16x32_bf16 v[128:131], v[20:23], v[160:163], v[128:131]
    v_mfma_f32_16x16x32_bf16 v[132:135], v[20:23], v[164:167], v[132:135]
    s_waitcnt vmcnt(6)
    v_mfma_f32_16x16x32_bf16 v[104:107], v[24:27], v[168:171], v[104:107]
    v_mfma_f32_16x16x32_bf16 v[108:111], v[24:27], v[172:175], v[108:111]
    v_mfma_f32_16x16x32_bf16 v[112:115], v[24:27], v[176:179], v[112:115]
    v_mfma_f32_16x16x32_bf16 v[116:119], v[24:27], v[180:183], v[116:119]
    s_waitcnt vmcnt(5)
    v_mfma_f32_16x16x32_bf16 v[120:123], v[28:31], v[168:171], v[120:123]
    v_mfma_f32_16x16x32_bf16 v[124:127], v[28:31], v[172:175], v[124:127]
    v_mfma_f32_16x16x32_bf16 v[128:131], v[28:31], v[176:179], v[128:131]
    v_mfma_f32_16x16x32_bf16 v[132:135], v[28:31], v[180:183], v[132:135]
    s_waitcnt vmcnt(4)
    v_mfma_f32_16x16x32_bf16 v[104:107], v[8:11], v[136:139], v[104:107]
    v_mfma_f32_16x16x32_bf16 v[108:111], v[8:11], v[140:143], v[108:111]
    v_mfma_f32_16x16x32_bf16 v[112:115], v[8:11], v[144:147], v[112:115]
    v_mfma_f32_16x16x32_bf16 v[116:119], v[8:11], v[148:151], v[116:119]
    s_cmp_lt_u32 s2, 224
    s_cbranch_scc0 L_else_188
    s_waitcnt vmcnt(0)
    s_lshl_b32 s48, s63, 12
    s_lshl_b32 s49, s61, 7
    s_add_u32 s48, s48, s49
    s_add_u32 s48, s48, 19136512
    v_lshl_add_u32 v68, v1, 4, s48
    v_mov_b32 v64, s44
    v_mov_b32 v65, s45
    v_mov_b32 v66, s44
    v_mov_b32 v67, s45
    s_mov_b64 exec, 255
    global_store_dwordx4 v68, v[64:67], s[38:39] sc1
    s_mov_b64 exec, -1
L_else_188:
    global_load_dwordx4 v[32:35], v6, s[38:39] offset:2048 sc1
    global_load_dwordx4 v[36:39], v6, s[38:39] offset:3072 sc1
    global_load_dwordx4 v[40:43], v7, s[38:39] offset:-4096 sc1
    global_load_dwordx4 v[44:47], v7, s[38:39] offset:-3072 sc1
    global_load_dwordx4 v[48:51], v7, s[38:39] offset:-2048 sc1
    global_load_dwordx4 v[52:55], v7, s[38:39] offset:-1024 sc1
    global_load_dwordx4 v[56:59], v7, s[38:39] offset:0 sc1
    global_load_dwordx4 v[60:63], v7, s[38:39] offset:1024 sc1
    global_load_dword v70, v2, s[38:39] sc1
    v_add_u32 v250, 131072, v250
    v_add_u32 v2, 16384, v2
    v_add_u32 v6, 3670016, v6
    v_add_u32 v7, 3670016, v7
    v_add_u32 v5, 1048576, v5
    v_lshrrev_b32 v248, 5, v1
    v_and_b32 v255, 7, v1
    v_lshl_add_u32 v255, v248, 3, v255
    v_mul_u32_u24 v248, 288, v255
    v_lshl_add_u32 v248, v3, 2, v248
    v_add_u32 v248, 131072, v248
    v_lshlrev_b32 v249, 4, v255
    v_add_u32 v249, 163584, v249
    s_lshl_b32 s48, s22, 15
    s_lshl_b32 s49, s23, 7
    s_add_u32 s48, s48, s49
    v_lshlrev_b32 v251, 10, v3
    v_lshl_add_u32 v251, v255, 3, v251
    v_add_u32 v251, s48, v251
    s_waitcnt vmcnt(8)
    v_mfma_f32_16x16x32_bf16 v[104:107], v[32:35], v[184:187], v[104:107]
    v_mfma_f32_16x16x32_bf16 v[108:111], v[32:35], v[188:191], v[108:111]
    v_mfma_f32_16x16x32_bf16 v[112:115], v[32:35], v[192:195], v[112:115]
    v_mfma_f32_16x16x32_bf16 v[116:119], v[32:35], v[196:199], v[116:119]
    s_waitcnt vmcnt(7)
    v_mfma_f32_16x16x32_bf16 v[120:123], v[36:39], v[184:187], v[120:123]
    v_mfma_f32_16x16x32_bf16 v[124:127], v[36:39], v[188:191], v[124:127]
    v_mfma_f32_16x16x32_bf16 v[128:131], v[36:39], v[192:195], v[128:131]
    v_mfma_f32_16x16x32_bf16 v[132:135], v[36:39], v[196:199], v[132:135]
    s_waitcnt vmcnt(6)
    v_mfma_f32_16x16x32_bf16 v[104:107], v[40:43], v[200:203], v[104:107]
    v_mfma_f32_16x16x32_bf16 v[108:111], v[40:43], v[204:207], v[108:111]
    v_mfma_f32_16x16x32_bf16 v[112:115], v[40:43], v[208:211], v[112:115]
    v_mfma_f32_16x16x32_bf16 v[116:119], v[40:43], v[212:215], v[116:119]
    s_waitcnt vmcnt(5)
    v_mfma_f32_16x16x32_bf16 v[120:123], v[44:47], v[200:203], v[120:123]
    v_mfma_f32_16x16x32_bf16 v[124:127], v[44:47], v[204:207], v[124:127]
    v_mfma_f32_16x16x32_bf16 v[128:131], v[44:47], v[208:211], v[128:131]
    v_mfma_f32_16x16x32_bf16 v[132:135], v[44:47], v[212:215], v[132:135]
    s_mov_b64 exec, 15
    v_mov_b32 v252, 0
    v_mov_b32 v253, 0
    global_atomic_add_x2 v[252:253], v250, v[252:253], s[38:39] sc0 sc1
    s_mov_b64 exec, -1
    s_waitcnt vmcnt(5)
    v_mfma_f32_16x16x32_bf16 v[104:107], v[48:51], v[216:219], v[104:107]
    v_mfma_f32_16x16x32_bf16 v[108:111], v[48:51], v[220:223], v[108:111]
    v_mfma_f32_16x16x32_bf16 v[112:115], v[48:51], v[224:227], v[112:115]
    v_mfma_f32_16x16x32_bf16 v[116:119], v[48:51], v[228:231], v[116:119]
    s_waitcnt vmcnt(4)
    v_mfma_f32_16x16x32_bf16 v[120:123], v[52:55], v[216:219], v[120:123]
    v_mfma_f32_16x16x32_bf16 v[124:127], v[52:55], v[220:223], v[124:127]
    v_mfma_f32_16x16x32_bf16 v[128:131], v[52:55], v[224:227], v[128:131]
    v_mfma_f32_16x16x32_bf16 v[132:135], v[52:55], v[228:231], v[132:135]
    s_waitcnt vmcnt(3)
    v_mfma_f32_16x16x32_bf16 v[104:107], v[56:59], v[232:235], v[104:107]
    v_mfma_f32_16x16x32_bf16 v[108:111], v[56:59], v[236:239], v[108:111]
    v_mfma_f32_16x16x32_bf16 v[112:115], v[56:59], v[240:243], v[112:115]
    v_mfma_f32_16x16x32_bf16 v[116:119], v[56:59], v[244:247], v[116:119]
    s_waitcnt vmcnt(2)
    v_mfma_f32_16x16x32_bf16 v[120:123], v[60:63], v[232:235], v[120:123]
    v_mfma_f32_16x16x32_bf16 v[124:127], v[60:63], v[236:239], v[124:127]
    v_mfma_f32_16x16x32_bf16 v[128:131], v[60:63], v[240:243], v[128:131]
    v_mfma_f32_16x16x32_bf16 v[132:135], v[60:63], v[244:247], v[132:135]
    s_waitcnt vmcnt(0)
    s_mov_b64 exec, 15
L_chk_190:
    v_cmp_ne_u64 vcc, s[44:45], v[252:253]
    s_cbranch_vccnz L_again_192
L_ok_191:
    s_mov_b64 exec, -1
    global_load_dwordx4 v[8:11], v6, s[38:39] offset:-4096 sc1
    global_load_dwordx4 v[12:15], v6, s[38:39] offset:-3072 sc1
    global_load_dwordx4 v[16:19], v6, s[38:39] offset:-2048 sc1
    global_load_dwordx4 v[20:23], v6, s[38:39] offset:-1024 sc1
    global_load_dwordx4 v[24:27], v6, s[38:39] offset:0 sc1
    v_mov_b32 v66, 161792
L_cw_193:
    ds_read2_b32 v[64:65], v66 offset0:18 offset1:19
    s_waitcnt lgkmcnt(0)
    v_min_u32 v64, v64, v65
    v_cmp_gt_u32 vcc, 4, v64
    s_cbranch_vccnz L_cw_193
    s_lshl_b32 s48, s3, 13
    s_add_u32 m0, s48, 0
    s_nop 0
    ds_write_addtid_b32 v104 offset:0
    ds_write_addtid_b32 v105 offset:512
    ds_write_addtid_b32 v106 offset:1024
    ds_write_addtid_b32 v107 offset:1536
    ds_write_addtid_b32 v108 offset:4096
    ds_write_addtid_b32 v109 offset:4608
    ds_write_addtid_b32 v110 offset:5120
    ds_write_addtid_b32 v111 offset:5632
    ds_write_addtid_b32 v112 offset:256
    ds_write_addtid_b32 v113 offset:768
    ds_write_addtid_b32 v114 offset:1280
    ds_write_addtid_b32 v115 offset:1792
    ds_write_addtid_b32 v116 offset:4352
    ds_write_addtid_b32 v117 offset:4864
    ds_write_addtid_b32 v118 offset:5376
    ds_write_addtid_b32 v119 offset:5888
    ds_write_addtid_b32 v120 offset:2048
    ds_write_addtid_b32 v121 offset:2560
    ds_write_addtid_b32 v122 offset:3072
    ds_write_addtid_b32 v123 offset:3584
    ds_write_addtid_b32 v124 offset:6144
    ds_write_addtid_b32 v125 offset:6656
    ds_write_addtid_b32 v126 offset:7168
    ds_write_addtid_b32 v127 offset:7680
    ds_write_addtid_b32 v128 offset:2304
    ds_write_addtid_b32 v129 offset:2816
    ds_write_addtid_b32 v130 offset:3328
    ds_write_addtid_b32 v131 offset:3840
    ds_write_addtid_b32 v132 offset:6400
    ds_write_addtid_b32 v133 offset:6912
    ds_write_addtid_b32 v134 offset:7424
    ds_write_addtid_b32 v135 offset:7936
    v_mov_b32 v64, 161792
    v_mov_b32 v65, 1
    s_mov_b64 exec, 1
    ds_add_u32 v64, v65 offset:60
    s_mov_b64 exec, -1
    s_waitcnt vmcnt(4)
    v_mfma_f32_16x16x32_bf16 v[104:107], v[8:11], v[136:139], 0
    v_mfma_f32_16x16x32_bf16 v[108:111], v[8:11], v[140:143], 0
    v_mfma_f32_16x16x32_bf16 v[112:115], v[8:11], v[144:147], 0
    v_mfma_f32_16x16x32_bf16 v[116:119], v[8:11], v[148:151], 0
    global_load_dwordx4 v[28:31], v6, s[38:39] offset:1024 sc1
    s_waitcnt vmcnt(4)
    v_mfma_f32_16x16x32_bf16 v[120:123], v[12:15], v[136:139], 0
    v_mfma_f32_16x16x32_bf16 v[124:127], v[12:15], v[140:143], 0
    v_mfma_f32_16x16x32_bf16 v[128:131], v[12:15], v[144:147], 0
    v_mfma_f32_16x16x32_bf16 v[132:135], v[12:15], v[148:151], 0
    global_load_dwordx4 v[32:35], v6, s[38:39] offset:2048 sc1
    s_waitcnt vmcnt(4)
    v_mfma_f32_16x16x32_bf16 v[104:107], v[16:19], v[152:155], v[104:107]
    v_mfma_f32_16x16x32_bf16 v[108:111], v[16:19], v[156:159], v[108:111]
    v_mfma_f32_16x16x32_bf16 v[112:115], v[16:19], v[160:163], v[112:115]
    v_mfma_f32_16x16x32_bf16 v[116:119], v[16:19], v[164:167], v[116:119]
    global_load_dwordx4 v[36:39], v6, s[38:39] offset:3072 sc1
    s_waitcnt vmcnt(4)
    v_mfma_f32_16x16x32_bf16 v[120:123], v[20:23], v[152:155], v[120:123]
    v_mfma_f32_16x16x32_bf16 v[124:127], v[20:23], v[156:159], v[124:127]
    v_mfma_f32_16x16x32_bf16 v[128:131], v[20:23], v[160:163], v[128:131]
    v_mfma_f32_16x16x32_bf16 v[132:135], v[20:23], v[164:167], v[132:135]
    global_load_dwordx4 v[40:43], v7, s[38:39] offset:-4096 sc1
    s_waitcnt vmcnt(4)
    v_mfma_f32_16x16x32_bf16 v[104:107], v[24:27], v[168:171], v[104:107]
    v_mfma_f32_16x16x32_bf16 v[108:111], v[24:27], v[172:175], v[108:111]
    v_mfma_f32_16x16x32_bf16 v[112:115], v[24:27], v[176:179], v[112:115]
    v_mfma_f32_16x16x32_bf16 v[116:119], v[24:27], v[180:183], v[116:119]
    global_load_dwordx4 v[44:47], v7, s[38:39] offset:-3072 sc1
    v_mov_b32 v22, 161792
L_cw_195:
    ds_read2_b32 v[20:21], v22 offset0:14 offset1:15
    s_waitcnt lgkmcnt(0)
    v_min_u32 v20, v20, v21
    v_cmp_gt_u32 vcc, 4, v20
    s_cbranch_vccz L_cok_196
    s_sleep 1
    s_branch L_cw_195
L_cok_196:
    ds_read_b128 v[8:11], v249
    v_lshlrev_b32 v254, 16, v70
    v_rcp_f32 v254, v254
    s_nop 0
    v_mul_f32 v254, v254, v254
    s_waitcnt lgkmcnt(0)
    v_mul_f32 v8, v254, v8
    v_mul_f32 v9, v254, v9
    v_mul_f32 v10, v254, v10
    v_mul_f32 v11, v254, v11
    ds_read2_b32 v[12:13], v248 offset0:0 offset1:36
    ds_read_b64 v[72:73], v4 offset:0
    ds_read_b64 v[74:75], v4 offset:4096
    ds_read_b64 v[76:77], v4 offset:8192
    ds_read_b64 v[78:79], v4 offset:12288
    ds_read_b64 v[80:81], v4 offset:16384
    ds_read_b64 v[82:83], v4 offset:20480
    ds_read_b64 v[84:85], v4 offset:24576
    ds_read_b64 v[86:87], v4 offset:28672
    ds_read_b64 v[88:89], v4 offset:32768
    ds_read_b64 v[90:91], v4 offset:36864
    ds_read_b64 v[92:93], v4 offset:40960
    ds_read_b64 v[94:95], v4 offset:45056
    ds_read_b64 v[96:97], v4 offset:49152
    ds_read_b64 v[98:99], v4 offset:53248
    ds_read_b64 v[100:101], v4 offset:57344
    ds_read_b64 v[102:103], v4 offset:61440
    s_waitcnt lgkmcnt(15)
    v_lshlrev_b32 v16, 16, v12
    v_and_b32 v17, 0xffff0000, v12
    v_lshlrev_b32 v18, 16, v13
    v_and_b32 v19, 0xffff0000, v13
    s_waitcnt lgkmcnt(12)
    v_add_f32 v72, v72, v76
    v_add_f32 v73, v73, v77
    v_add_f32 v74, v74, v78
    v_add_f32 v75, v75, v79
    s_waitcnt lgkmcnt(10)
    v_add_f32 v72, v72, v80
    v_add_f32 v73, v73, v81
    v_add_f32 v74, v74, v82
    v_add_f32 v75, v75, v83
    s_waitcnt lgkmcnt(8)
    v_add_f32 v72, v72, v84
    v_add_f32 v73, v73, v85
    v_add_f32 v74, v74, v86
    v_add_f32 v75, v75, v87
    s_waitcnt lgkmcnt(6)
    v_add_f32 v72, v72, v88
    v_add_f32 v73, v73, v89
    v_add_f32 v74, v74, v90
    v_add_f32 v75, v75, v91
    s_waitcnt lgkmcnt(4)
    v_add_f32 v72, v72, v92
    v_add_f32 v73, v73, v93
    v_add_f32 v74, v74, v94
    v_add_f32 v75, v75, v95
    s_waitcnt lgkmcnt(2)
    v_add_f32 v72, v72, v96
    v_add_f32 v73, v73, v97
    v_add_f32 v74, v74, v98
    v_add_f32 v75, v75, v99
    s_waitcnt lgkmcnt(0)
    v_add_f32 v72, v72, v100
    v_add_f32 v73, v73, v101
    v_add_f32 v74, v74, v102
    v_add_f32 v75, v75, v103
    v_fmac_f32 v16, v8, v72
    v_fmac_f32 v17, v9, v74
    v_fmac_f32 v18, v10, v73
    v_fmac_f32 v19, v11, v75
    v_cvt_pk_bf16_f32 v14, v16, v17
    v_cvt_pk_bf16_f32 v15, v18, v19
    global_store_dwordx2 v251, v[14:15], s[34:35]
    s_waitcnt vmcnt(5)
    v_mfma_f32_16x16x32_bf16 v[120:123], v[28:31], v[168:171], v[120:123]
    v_mfma_f32_16x16x32_bf16 v[124:127], v[28:31], v[172:175], v[124:127]
    v_mfma_f32_16x16x32_bf16 v[128:131], v[28:31], v[176:179], v[128:131]
    v_mfma_f32_16x16x32_bf16 v[132:135], v[28:31], v[180:183], v[132:135]
    global_load_dwordx4 v[48:51], v7, s[38:39] offset:-2048 sc1
    s_waitcnt vmcnt(5)
    v_mfma_f32_16x16x32_bf16 v[104:107], v[32:35], v[184:187], v[104:107]
    v_mfma_f32_16x16x32_bf16 v[108:111], v[32:35], v[188:191], v[108:111]
    v_mfma_f32_16x16x32_bf16 v[112:115], v[32:35], v[192:195], v[112:115]
    v_mfma_f32_16x16x32_bf16 v[116:119], v[32:35], v[196:199], v[116:119]
    global_load_dwordx4 v[52:55], v7, s[38:39] offset:-1024 sc1
    s_waitcnt vmcnt(5)
    v_mfma_f32_16x16x32_bf16 v[120:123], v[36:39], v[184:187], v[120:123]
    v_mfma_f32_16x16x32_bf16 v[124:127], v[36:39], v[188:191], v[124:127]
    v_mfma_f32_16x16x32_bf16 v[128:131], v[36:39], v[192:195], v[128:131]
    v_mfma_f32_16x16x32_bf16 v[132:135], v[36:39], v[196:199], v[132:135]
    global_load_dwordx4 v[56:59], v7, s[38:39] offset:0 sc1
    s_waitcnt vmcnt(5)
    v_mfma_f32_16x16x32_bf16 v[104:107], v[40:43], v[200:203], v[104:107]
    v_mfma_f32_16x16x32_bf16 v[108:111], v[40:43], v[204:207], v[108:111]
    v_mfma_f32_16x16x32_bf16 v[112:115], v[40:43], v[208:211], v[112:115]
    v_mfma_f32_16x16x32_bf16 v[116:119], v[40:43], v[212:215], v[116:119]
    global_load_dwordx4 v[60:63], v7, s[38:39] offset:1024 sc1
    s_waitcnt vmcnt(5)
    v_mfma_f32_16x16x32_bf16 v[120:123], v[44:47], v[200:203], v[120:123]
    v_mfma_f32_16x16x32_bf16 v[124:127], v[44:47], v[204:207], v[124:127]
    v_mfma_f32_16x16x32_bf16 v[128:131], v[44:47], v[208:211], v[128:131]
    v_mfma_f32_16x16x32_bf16 v[132:135], v[44:47], v[212:215], v[132:135]
    global_load_dword v71, v2, s[38:39] sc1
    s_waitcnt vmcnt(4)
    v_mfma_f32_16x16x32_bf16 v[104:107], v[48:51], v[216:219], v[104:107]
    v_mfma_f32_16x16x32_bf16 v[108:111], v[48:51], v[220:223], v[108:111]
    v_mfma_f32_16x16x32_bf16 v[112:115], v[48:51], v[224:227], v[112:115]
    v_mfma_f32_16x16x32_bf16 v[116:119], v[48:51], v[228:231], v[116:119]
    s_waitcnt vmcnt(3)
    v_mfma_f32_16x16x32_bf16 v[120:123], v[52:55], v[216:219], v[120:123]
    v_mfma_f32_16x16x32_bf16 v[124:127], v[52:55], v[220:223], v[124:127]
    v_mfma_f32_16x16x32_bf16 v[128:131], v[52:55], v[224:227], v[128:131]
    v_mfma_f32_16x16x32_bf16 v[132:135], v[52:55], v[228:231], v[132:135]
    s_waitcnt vmcnt(2)
    v_mfma_f32_16x16x32_bf16 v[104:107], v[56:59], v[232:235], v[104:107]
    v_mfma_f32_16x16x32_bf16 v[108:111], v[56:59], v[236:239], v[108:111]
    v_mfma_f32_16x16x32_bf16 v[112:115], v[56:59], v[240:243], v[112:115]
    v_mfma_f32_16x16x32_bf16 v[116:119], v[56:59], v[244:247], v[116:119]
    s_waitcnt vmcnt(1)
    v_mfma_f32_16x16x32_bf16 v[120:123], v[60:63], v[232:235], v[120:123]
    v_mfma_f32_16x16x32_bf16 v[124:127], v[60:63], v[236:239], v[124:127]
    v_mfma_f32_16x16x32_bf16 v[128:131], v[60:63], v[240:243], v[128:131]
    v_mfma_f32_16x16x32_bf16 v[132:135], v[60:63], v[244:247], v[132:135]
    s_waitcnt vmcnt(0)
    s_lshl_b32 s48, s3, 13
    s_add_u32 m0, s48, 65536
    s_nop 0
    ds_write_addtid_b32 v104 offset:0
    ds_write_addtid_b32 v105 offset:512
    ds_write_addtid_b32 v106 offset:1024
    ds_write_addtid_b32 v107 offset:1536
    ds_write_addtid_b32 v108 offset:4096
    ds_write_addtid_b32 v109 offset:4608
    ds_write_addtid_b32 v110 offset:5120
    ds_write_addtid_b32 v111 offset:5632
    ds_write_addtid_b32 v112 offset:256
    ds_write_addtid_b32 v113 offset:768
    ds_write_addtid_b32 v114 offset:1280
    ds_write_addtid_b32 v115 offset:1792
    ds_write_addtid_b32 v116 offset:4352
    ds_write_addtid_b32 v117 offset:4864
    ds_write_addtid_b32 v118 offset:5376
    ds_write_addtid_b32 v119 offset:5888
    ds_write_addtid_b32 v120 offset:2048
    ds_write_addtid_b32 v121 offset:2560
    ds_write_addtid_b32 v122 offset:3072
    ds_write_addtid_b32 v123 offset:3584
    ds_write_addtid_b32 v124 offset:6144
    ds_write_addtid_b32 v125 offset:6656
    ds_write_addtid_b32 v126 offset:7168
    ds_write_addtid_b32 v127 offset:7680
    ds_write_addtid_b32 v128 offset:2304
    ds_write_addtid_b32 v129 offset:2816
    ds_write_addtid_b32 v130 offset:3328
    ds_write_addtid_b32 v131 offset:3840
    ds_write_addtid_b32 v132 offset:6400
    ds_write_addtid_b32 v133 offset:6912
    ds_write_addtid_b32 v134 offset:7424
    ds_write_addtid_b32 v135 offset:7936
L_end_168:
    ds_read_b128 v[8:11], v249
    v_lshlrev_b32 v254, 16, v71
    v_rcp_f32 v254, v254
    s_nop 0
    v_mul_f32 v254, v254, v254
    s_waitcnt lgkmcnt(0)
    v_mul_f32 v8, v254, v8
    v_mul_f32 v9, v254, v9
    v_mul_f32 v10, v254, v10
    v_mul_f32 v11, v254, v11
    v_add_u32 v4, 0x10000, v4
    v_add_u32 v248, 4608, v248
    v_add_u32 v251, 1048576, v251
    s_waitcnt lgkmcnt(0)
    s_barrier
    ds_read2_b32 v[12:13], v248 offset0:0 offset1:36
    ds_read_b64 v[72:73], v4 offset:0
    ds_read_b64 v[74:75], v4 offset:4096
    ds_read_b64 v[76:77], v4 offset:8192
    ds_read_b64 v[78:79], v4 offset:12288
    ds_read_b64 v[80:81], v4 offset:16384
    ds_read_b64 v[82:83], v4 offset:20480
    ds_read_b64 v[84:85], v4 offset:24576
    ds_read_b64 v[86:87], v4 offset:28672
    ds_read_b64 v[88:89], v4 offset:32768
    ds_read_b64 v[90:91], v4 offset:36864
    ds_read_b64 v[92:93], v4 offset:40960
    ds_read_b64 v[94:95], v4 offset:45056
    ds_read_b64 v[96:97], v4 offset:49152
    ds_read_b64 v[98:99], v4 offset:53248
    ds_read_b64 v[100:101], v4 offset:57344
    ds_read_b64 v[102:103], v4 offset:61440
    s_waitcnt lgkmcnt(15)
    v_lshlrev_b32 v16, 16, v12
    v_and_b32 v17, 0xffff0000, v12
    v_lshlrev_b32 v18, 16, v13
    v_and_b32 v19, 0xffff0000, v13
    s_waitcnt lgkmcnt(12)
    v_pk_add_f32 v[72:73], v[72:73], v[76:77]
    v_pk_add_f32 v[74:75], v[74:75], v[78:79]
    s_waitcnt lgkmcnt(10)
    v_pk_add_f32 v[72:73], v[72:73], v[80:81]
    v_pk_add_f32 v[74:75], v[74:75], v[82:83]
    s_waitcnt lgkmcnt(8)
    v_pk_add_f32 v[72:73], v[72:73], v[84:85]
    v_pk_add_f32 v[74:75], v[74:75], v[86:87]
    s_waitcnt lgkmcnt(6)
    v_pk_add_f32 v[72:73], v[72:73], v[88:89]
    v_pk_add_f32 v[74:75], v[74:75], v[90:91]
    s_waitcnt lgkmcnt(4)
    v_pk_add_f32 v[72:73], v[72:73], v[92:93]
    v_pk_add_f32 v[74:75], v[74:75], v[94:95]
    s_waitcnt lgkmcnt(2)
    v_pk_add_f32 v[72:73], v[72:73], v[96:97]
    v_pk_add_f32 v[74:75], v[74:75], v[98:99]
    s_waitcnt lgkmcnt(0)
    v_pk_add_f32 v[72:73], v[72:73], v[100:101]
    v_pk_add_f32 v[74:75], v[74:75], v[102:103]
    v_fmac_f32 v16, v8, v72
    v_fmac_f32 v17, v9, v74
    v_fmac_f32 v18, v10, v73
    v_fmac_f32 v19, v11, v75
    v_cvt_pk_bf16_f32 v14, v16, v17
    v_cvt_pk_bf16_f32 v15, v18, v19
    global_store_dwordx2 v251, v[14:15], s[34:35]
    s_endpgm
L_again_37:
    s_add_u32 s58, s58, 1
    s_cmp_gt_u32 s58, 0x40000
    s_cbranch_scc1 L_ok_36
    s_sleep 1
    s_mov_b64 exec, vcc
    global_load_dwordx2 v[32:33], v13, s[38:39] sc1
    s_waitcnt vmcnt(0)
    s_branch L_chk_35
L_again_42:
    s_add_u32 s58, s58, 1
    s_cmp_gt_u32 s58, 0x40000
    s_cbranch_scc1 L_ok_41
    s_sleep 1
    s_mov_b64 exec, vcc
    global_load_dwordx4 v[48:51], v15, s[38:39] sc1
    global_load_dwordx4 v[40:43], v14, s[38:39] sc1
    global_load_dwordx4 v[44:47], v31, s[38:39] sc1
    s_waitcnt vmcnt(0)
    s_branch L_chk_40
L_again_56:
    s_add_u32 s58, s58, 1
    s_cmp_gt_u32 s58, 0x40000
    s_cbranch_scc1 L_ok_55
    s_sleep 1
    s_mov_b64 exec, vcc
    v_mov_b32 v254, 0
    v_mov_b32 v255, 0
    global_atomic_add_x2 v[254:255], v251, v[254:255], s[38:39] sc0 sc1
    s_waitcnt vmcnt(0)
    s_branch L_chk_54
L_again_59:
    s_add_u32 s58, s58, 1
    s_cmp_gt_u32 s58, 0x40000
    s_cbranch_scc1 L_ok_58
    s_sleep 1
    s_mov_b64 exec, vcc
    global_load_dwordx2 v[60:61], v70, s[38:39] sc1
    s_waitcnt vmcnt(0)
    s_branch L_chk_57
L_again_63:
    s_add_u32 s58, s58, 1
    s_cmp_gt_u32 s58, 0x40000
    s_cbranch_scc1 L_ok_62
    s_sleep 1
    s_mov_b64 exec, vcc
    global_load_dwordx4 v[128:131], v30, s[38:39] offset:0 sc1
    global_load_dwordx4 v[132:135], v30, s[38:39] offset:512 sc1
    global_load_dwordx4 v[136:139], v30, s[38:39] offset:1024 sc1
    global_load_dwordx4 v[140:143], v30, s[38:39] offset:1536 sc1
    global_load_dwordx4 v[144:147], v31, s[38:39] offset:0 sc1
    global_load_dwordx4 v[148:151], v31, s[38:39] offset:512 sc1
    global_load_dwordx4 v[152:155], v31, s[38:39] offset:1024 sc1
    global_load_dwordx4 v[156:159], v31, s[38:39] offset:1536 sc1
    s_waitcnt vmcnt(0)
    s_branch L_chk_61
L_again_68:
    s_add_u32 s58, s58, 1
    s_cmp_gt_u32 s58, 0x40000
    s_cbranch_scc1 L_ok_67
    s_sleep 1
    s_mov_b64 exec, vcc
    global_load_dwordx2 v[60:61], v70, s[38:39] sc1
    s_waitcnt vmcnt(0)
    s_branch L_chk_66
L_again_76:
    s_add_u32 s58, s58, 1
    s_cmp_gt_u32 s58, 0x40000
    s_cbranch_scc1 L_ok_75
    s_sleep 1
    s_mov_b64 exec, vcc
    global_load_dwordx2 v[32:33], v13, s[38:39] sc1
    s_waitcnt vmcnt(0)
    s_branch L_chk_74
L_again_85:
    s_add_u32 s58, s58, 1
    s_cmp_gt_u32 s58, 0x40000
    s_cbranch_scc1 L_ok_84
    s_sleep 1
    s_mov_b64 exec, vcc
    global_load_dwordx4 v[40:43], v14, s[38:39] sc1
    global_load_dwordx4 v[44:47], v31, s[38:39] sc1
    s_waitcnt vmcnt(0)
    s_branch L_chk_83
L_again_97:
    s_add_u32 s58, s58, 1
    s_cmp_gt_u32 s58, 0x40000
    s_cbranch_scc1 L_ok_96
    s_sleep 1
    s_mov_b64 exec, vcc
    global_load_dwordx4 v[8:11], v24, s[38:39] offset:0 sc1
    global_load_dwordx4 v[12:15], v24, s[38:39] offset:512 sc1
    global_load_dwordx4 v[16:19], v24, s[38:39] offset:1024 sc1
    global_load_dwordx4 v[20:23], v24, s[38:39] offset:1536 sc1
    s_waitcnt vmcnt(0)
    s_branch L_chk_95
L_again_100:
    s_add_u32 s58, s58, 1
    s_cmp_gt_u32 s58, 0x40000
    s_cbranch_scc1 L_ok_99
    s_sleep 1
    s_mov_b64 exec, vcc
    v_mov_b32 v254, 0
    v_mov_b32 v255, 0
    global_atomic_add_x2 v[254:255], v251, v[254:255], s[38:39] sc0 sc1
    s_waitcnt vmcnt(0)
    s_branch L_chk_98
L_again_105:
    s_add_u32 s58, s58, 1
    s_cmp_gt_u32 s58, 0x40000
    s_cbranch_scc1 L_ok_104
    s_sleep 1
    s_mov_b64 exec, vcc
    global_load_dwordx2 v[60:61], v70, s[38:39] sc1
    s_waitcnt vmcnt(0)
    s_branch L_chk_103
L_again_110:
    s_add_u32 s58, s58, 1
    s_cmp_gt_u32 s58, 0x40000
    s_cbranch_scc1 L_ok_109
    s_sleep 4
    s_mov_b64 exec, vcc
    global_load_dwordx4 v[40:43], v48, s[38:39] sc1
    global_load_dwordx4 v[44:47], v49, s[38:39] sc1
    s_waitcnt vmcnt(0)
    s_branch L_chk_108
L_again_124:
    s_add_u32 s58, s58, 1
    s_cmp_gt_u32 s58, 0x40000
    s_cbranch_scc1 L_ok_123
    s_sleep 2
    s_mov_b64 exec, vcc
    v_mov_b32 v252, 0
    v_mov_b32 v253, 0
    global_atomic_add_x2 v[252:253], v250, v[252:253], s[38:39] sc0 sc1
    s_waitcnt vmcnt(0)
    s_branch L_chk_122
L_again_145:
    s_add_u32 s58, s58, 1
    s_cmp_gt_u32 s58, 0x40000
    s_cbranch_scc1 L_ok_144
    s_sleep 4
    s_mov_b64 exec, vcc
    global_load_dwordx4 v[40:43], v48, s[38:39] sc1
    s_waitcnt vmcnt(0)
    s_branch L_chk_143
L_again_161:
    s_add_u32 s58, s58, 1
    s_cmp_gt_u32 s58, 0x40000
    s_cbranch_scc1 L_ok_160
    s_sleep 1
    s_mov_b64 exec, vcc
    v_mov_b32 v254, 0
    v_mov_b32 v255, 0
    global_atomic_add_x2 v[254:255], v251, v[254:255], s[38:39] sc0 sc1
    s_waitcnt vmcnt(0)
    s_branch L_chk_159
L_again_166:
    s_add_u32 s58, s58, 1
    s_cmp_gt_u32 s58, 0x40000
    s_cbranch_scc1 L_ok_165
    s_sleep 8
    s_mov_b64 exec, vcc
    v_mov_b32 v252, 0
    v_mov_b32 v253, 0
    global_atomic_add_x2 v[252:253], v250, v[252:253], s[38:39] sc0 sc1
    s_waitcnt vmcnt(0)
    s_branch L_chk_164
L_again_173:
    s_add_u32 s58, s58, 1
    s_cmp_gt_u32 s58, 0x40000
    s_cbranch_scc1 L_ok_172
    s_sleep 4
    s_mov_b64 exec, vcc
    v_mov_b32 v252, 0
    v_mov_b32 v253, 0
    global_atomic_add_x2 v[252:253], v250, v[252:253], s[38:39] sc0 sc1
    s_waitcnt vmcnt(0)
    s_branch L_chk_171
L_again_176:
    s_add_u32 s58, s58, 1
    s_cmp_gt_u32 s58, 0x40000
    s_cbranch_scc1 L_ok_175
    s_sleep 4
    s_mov_b64 exec, vcc
    v_mov_b32 v252, 0
    v_mov_b32 v253, 0
    global_atomic_add_x2 v[252:253], v250, v[252:253], s[38:39] sc0 sc1
    s_waitcnt vmcnt(0)
    s_branch L_chk_174
L_again_182:
    s_add_u32 s58, s58, 1
    s_cmp_gt_u32 s58, 0x40000
    s_cbranch_scc1 L_ok_181
    s_sleep 2
    s_mov_b64 exec, vcc
    v_mov_b32 v252, 0
    v_mov_b32 v253, 0
    global_atomic_add_x2 v[252:253], v250, v[252:253], s[38:39] sc0 sc1
    s_waitcnt vmcnt(0)
    s_branch L_chk_180
L_again_192:
    s_add_u32 s58, s58, 1
    s_cmp_gt_u32 s58, 0x40000
    s_cbranch_scc1 L_ok_191
    s_sleep 2
    s_mov_b64 exec, vcc
    v_mov_b32 v252, 0
    v_mov_b32 v253, 0
    global_atomic_add_x2 v[252:253], v250, v[252:253], s[38:39] sc0 sc1
    s_waitcnt vmcnt(0)
    s_branch L_chk_190
L_exit:
    s_endpgm
.p2align 7
.type lag_table,@object
lag_table:
.long 0x14141414, 0x38141414, 0x383838, 0x40010
.long 0x14141414, 0x14141414, 0x383838, 0x40034
.long 0x14141414, 0x38141414, 0x383838, 0x40058
.long 0x14141414, 0x14141414, 0x383838, 0x4007c
.long 0x14141414, 0x38141414, 0x383838, 0x400a0
.long 0x14141414, 0x14141414, 0x383838, 0x400c4
.long 0x14141414, 0x38141414, 0x383838, 0x400e8
.long 0x14141414, 0x14141414, 0x383838, 0x4010c
.long 0x14141414, 0x38141414, 0x383838, 0x40130
.long 0x14141414, 0x14141414, 0x383838, 0x40154
.long 0x14141414, 0x38141414, 0x383838, 0x40178
.long 0x14141414, 0x14141414, 0x383838, 0x4019c
.long 0x14141414, 0x38141414, 0x383838, 0x401c0
.long 0x14141414, 0x14141414, 0x383838, 0x401e4
.long 0x14141414, 0x38141414, 0x383838, 0x40208
.long 0x14141414, 0x14141414, 0x383838, 0x4022c
.long 0x14141414, 0x38141414, 0x383838, 0x40020
.long 0x14141414, 0x14141414, 0x383838, 0x40044
.long 0x14141414, 0x38141414, 0x383838, 0x40068
.long 0x14141414, 0x14141414, 0x383838, 0x4008c
.long 0x14141414, 0x38141414, 0x383838, 0x400b0
.long 0x14141414, 0x14141414, 0x383838, 0x400d4
.long 0x14141414, 0x38141414, 0x383838, 0x400f8
.long 0x14141414, 0x14141414, 0x383838, 0x4011c
.long 0x14141414, 0x38141414, 0x383838, 0x40140
.long 0x14141414, 0x14141414, 0x383838, 0x40164
.long 0x14141414, 0x38141414, 0x383838, 0x40188
.long 0x14141414, 0x14141414, 0x383838, 0x401ac
.long 0x14141414, 0x38141414, 0x383838, 0x401d0
.long 0x14141414, 0x14141414, 0x383838, 0x401f4
.long 0x14141414, 0x38141414, 0x383838, 0x40218
.long 0x14141414, 0x14141414, 0x383838, 0x4023c
.long 0x14141414, 0x38141414, 0x383838, 0x80490
.long 0x14141414, 0x14141414, 0x383838, 0x804b4
.long 0x14141414, 0x38141414, 0x383838, 0x804d8
.long 0x14141414, 0x14141414, 0x383838, 0x804fc
.long 0x14141414, 0x38141414, 0x383838, 0x80520
.long 0x14141414, 0x14141414, 0x383838, 0x80544
.long 0x14141414, 0x38141414, 0x383838, 0x80568
.long 0x14141414, 0x14141414, 0x383838, 0x8058c
.long 0x14141414, 0x38141414, 0x383838, 0x805b0
.long 0x14141414, 0x14141414, 0x383838, 0x805d4
.long 0x14141414, 0x38141414, 0x383838, 0x805f8
.long 0x14141414, 0x14141414, 0x383838, 0x8061c
.long 0x14141414, 0x38141414, 0x383838, 0x80640
.long 0x14141414, 0x14141414, 0x383838, 0x80664
.long 0x14141414, 0x38141414, 0x383838, 0x80688
.long 0x14141414, 0x14141414, 0x383838, 0x806ac
.long 0x14141414, 0x38141414, 0x383838, 0x4800910
.long 0x14141414, 0x14141414, 0x383838, 0x4800934
.long 0x14141414, 0x38141414, 0x383838, 0x4800958
.long 0x14141414, 0x14141414, 0x383838, 0x480097c
.long 0x14141414, 0x38141414, 0x383838, 0x48009a0
.long 0x14141414, 0x14141414, 0x383838, 0x48009c4
.long 0x14141414, 0x38141414, 0x383838, 0x48009e8
.long 0x14141414, 0x14141414, 0x383838, 0x4800a0c
.long 0x14141414, 0x38141414, 0x383838, 0x4800a30
.long 0x14141414, 0x14141414, 0x383838, 0x4800a54
.long 0x14141414, 0x38141414, 0x383838, 0x4800a78
.long 0x14141414, 0x14141414, 0x383838, 0x4800a9c
.long 0x14141414, 0x38141414, 0x383838, 0x4800ac0
.long 0x14141414, 0x14141414, 0x383838, 0x4800ae4
.long 0x14141414, 0x38141414, 0x383838, 0x4800b08
.long 0x14141414, 0x14141414, 0x383838, 0x4800b2c
.long 0x14141414, 0x38141414, 0x383838, 0x40250
.long 0x14141414, 0x14141414, 0x383838, 0x40274
.long 0x14141414, 0x38141414, 0x383838, 0x40298
.long 0x14141414, 0x14141414, 0x383838, 0x402bc
.long 0x14141414, 0x38141414, 0x383838, 0x402e0
.long 0x14141414, 0x14141414, 0x383838, 0x40304
.long 0x14141414, 0x38141414, 0x383838, 0x40328
.long 0x14141414, 0x14141414, 0x383838, 0x4034c
.long 0x14141414, 0x38141414, 0x383838, 0x40370
.long 0x14141414, 0x14141414, 0x383838, 0x40394
.long 0x14141414, 0x38141414, 0x383838, 0x403b8
.long 0x14141414, 0x14141414, 0x383838, 0x403dc
.long 0x14141414, 0x38141414, 0x383838, 0x40400
.long 0x14141414, 0x14141414, 0x383838, 0x40424
.long 0x14141414, 0x38141414, 0x383838, 0x40448
.long 0x14141414, 0x14141414, 0x383838, 0x4046c
.long 0x14141414, 0x38141414, 0x383838, 0x40260
.long 0x14141414, 0x14141414, 0x383838, 0x40284
.long 0x14141414, 0x38141414, 0x383838, 0x402a8
.long 0x14141414, 0x14141414, 0x383838, 0x402cc
.long 0x14141414, 0x38141414, 0x383838, 0x402f0
.long 0x14141414, 0x14141414, 0x383838, 0x40314
.long 0x14141414, 0x38141414, 0x383838, 0x40338
.long 0x14141414, 0x14141414, 0x383838, 0x4035c
.long 0x14141414, 0x38141414, 0x383838, 0x40380
.long 0x14141414, 0x14141414, 0x383838, 0x403a4
.long 0x14141414, 0x38141414, 0x383838, 0x403c8
.long 0x14141414, 0x14141414, 0x383838, 0x403ec
.long 0x14141414, 0x38141414, 0x383838, 0x40410
.long 0x14141414, 0x14141414, 0x383838, 0x40434
.long 0x14141414, 0x38141414, 0x383838, 0x40458
.long 0x14141414, 0x14141414, 0x383838, 0x4047c
.long 0x14141414, 0x38141414, 0x383838, 0x806d0
.long 0x14141414, 0x14141414, 0x383838, 0x806f4
.long 0x14141414, 0x38141414, 0x383838, 0x80718
.long 0x14141414, 0x14141414, 0x383838, 0x8073c
.long 0x14141414, 0x38141414, 0x383838, 0x80760
.long 0x14141414, 0x14141414, 0x383838, 0x80784
.long 0x14141414, 0x38141414, 0x383838, 0x807a8
.long 0x14141414, 0x14141414, 0x383838, 0x807cc
.long 0x14141414, 0x38141414, 0x383838, 0x807f0
.long 0x14141414, 0x14141414, 0x383838, 0x80814
.long 0x14141414, 0x38141414, 0x383838, 0x80838
.long 0x14141414, 0x14141414, 0x383838, 0x8085c
.long 0x14141414, 0x38141414, 0x383838, 0x80880
.long 0x14141414, 0x14141414, 0x383838, 0x808a4
.long 0x14141414, 0x38141414, 0x383838, 0x808c8
.long 0x14141414, 0x14141414, 0x383838, 0x808ec
.long 0x14141414, 0x38141414, 0x383838, 0x4800b50
.long 0x14141414, 0x14141414, 0x383838, 0x4800b74
.long 0x14141414, 0x38141414, 0x383838, 0x4800b98
.long 0x14141414, 0x14141414, 0x383838, 0x4800bbc
.long 0x14141414, 0x38141414, 0x383838, 0x4800be0
.long 0x14141414, 0x14141414, 0x383838, 0x4800c04
.long 0x14141414, 0x38141414, 0x383838, 0x4800c28
.long 0x14141414, 0x14141414, 0x383838, 0x4800c4c
.long 0x14141414, 0x38141414, 0x383838, 0x4800c70
.long 0x14141414, 0x14141414, 0x383838, 0x4800c94
.long 0x14141414, 0x38141414, 0x383838, 0x4800cb8
.long 0x14141414, 0x14141414, 0x383838, 0x4800cdc
.long 0x14141414, 0x38141414, 0x383838, 0x4800d00
.long 0x14141414, 0x14141414, 0x383838, 0x4800d24
.long 0x14141414, 0x38141414, 0x383838, 0x4800d48
.long 0x14141400, 0x14141414, 0x383838, 0x4800d6c
.long 0x14141400, 0x24241414, 0x383824, 0x4801690
.long 0x14141400, 0x24241414, 0x383824, 0x48016b4
.long 0x14141400, 0x24241414, 0x383824, 0x48016d8
.long 0x14141400, 0x24241414, 0x383824, 0x48016fc
.long 0x14141400, 0x24241414, 0x383824, 0x4801720
.long 0x14141400, 0x24241414, 0x383824, 0x4801744
.long 0x14141400, 0x24241414, 0x383824, 0x4801768
.long 0x14141400, 0x24241414, 0x383824, 0x480178c
.long 0x14141400, 0x24241414, 0x383824, 0x48017b0
.long 0x14141400, 0x24241414, 0x383824, 0x48017d4
.long 0x14141400, 0x24241414, 0x383824, 0x48017f8
.long 0x14141400, 0x24241414, 0x383824, 0x480181c
.long 0x14141400, 0x24241414, 0x383824, 0x4801840
.long 0x14141400, 0x24241414, 0x383824, 0x4801864
.long 0x14141400, 0x24241414, 0x383824, 0x4801888
.long 0x14141400, 0x24241414, 0x383824, 0x48018ac
.long 0x14141400, 0x24241414, 0x383824, 0x4800920
.long 0x14141400, 0x24241414, 0x383824, 0x4800944
.long 0x14141400, 0x24241414, 0x383824, 0x4800968
.long 0x14141400, 0x24241414, 0x383824, 0x480098c
.long 0x14141400, 0x24241414, 0x383824, 0x48009b0
.long 0x14141400, 0x24241414, 0x383824, 0x48009d4
.long 0x14141400, 0x24241414, 0x383824, 0x48009f8
.long 0x14141400, 0x24241414, 0x383824, 0x4800a1c
.long 0x14141400, 0x24241414, 0x383824, 0x4800a40
.long 0x14141400, 0x24241414, 0x383824, 0x4800a64
.long 0x14141400, 0x24241414, 0x383824, 0x4800a88
.long 0x14141400, 0x24241414, 0x383824, 0x4800aac
.long 0x14141400, 0x24241414, 0x383824, 0x4800ad0
.long 0x14141400, 0x24241414, 0x383824, 0x4800af4
.long 0x14141400, 0x24241414, 0x383824, 0x4800b18
.long 0x14141400, 0x24241414, 0x383824, 0x4800b3c
.long 0x14141400, 0x24241414, 0x383824, 0x41214
.long 0x14141400, 0x24241414, 0x383824, 0x41238
.long 0x14141400, 0x24241414, 0x383824, 0x4125c
.long 0x14141400, 0x24241414, 0x383824, 0x41280
.long 0x14141400, 0x24241414, 0x383824, 0x412a4
.long 0x14141400, 0x24241414, 0x383824, 0x412c8
.long 0x14141400, 0x24241414, 0x383824, 0x412ec
.long 0x14141400, 0x24241414, 0x383824, 0x41310
.long 0x14141400, 0x24241414, 0x383824, 0x41334
.long 0x14141400, 0x24241414, 0x383824, 0x41358
.long 0x14141400, 0x24241414, 0x383824, 0x4137c
.long 0x14141400, 0x24241414, 0x383824, 0x413a0
.long 0x14141400, 0x24241414, 0x383824, 0x413c4
.long 0x14141400, 0x24241414, 0x383824, 0x413e8
.long 0x14141400, 0x24241414, 0x383824, 0x4140c
.long 0x14141400, 0x24241414, 0x383824, 0x41430
.long 0x14141400, 0x24241414, 0x383824, 0x41214
.long 0x14141400, 0x24241414, 0x383824, 0x41238
.long 0x14141400, 0x24241414, 0x383824, 0x4125c
.long 0x14141400, 0x24241414, 0x383824, 0x41280
.long 0x14141400, 0x24241414, 0x383824, 0x412a4
.long 0x14141400, 0x24241414, 0x383824, 0x412c8
.long 0x14141400, 0x24241414, 0x383824, 0x412ec
.long 0x14141400, 0x24241414, 0x383824, 0x41310
.long 0x14141400, 0x24241414, 0x383824, 0x41334
.long 0x14141400, 0x24241414, 0x383824, 0x41358
.long 0x14141400, 0x24241414, 0x383824, 0x4137c
.long 0x14141400, 0x24241414, 0x383824, 0x413a0
.long 0x14141400, 0x24241414, 0x383824, 0x413c4
.long 0x14141400, 0x24241414, 0x383824, 0x413e8
.long 0x14141400, 0x24241414, 0x383824, 0x4140c
.long 0x14140800, 0x24241414, 0x383824, 0x41430
.long 0x14140800, 0x24241c14, 0x382c24, 0x48018d0
.long 0x14140800, 0x24241c14, 0x382c24, 0x48018f4
.long 0x14140800, 0x24241c14, 0x382c24, 0x4801918
.long 0x14140800, 0x24241c14, 0x382c24, 0x480193c
.long 0x14140800, 0x24241c14, 0x382c24, 0x4801960
.long 0x14140800, 0x24241c14, 0x382c24, 0x4801984
.long 0x14140800, 0x24241c14, 0x382c24, 0x48019a8
.long 0x14140800, 0x24241c14, 0x382c24, 0x48019cc
.long 0x14140800, 0x24241c14, 0x382c24, 0x48019f0
.long 0x14140800, 0x24241c14, 0x382c24, 0x4801a14
.long 0x14140800, 0x24241c14, 0x382c24, 0x4801a38
.long 0x14140800, 0x24241c14, 0x382c24, 0x4801a5c
.long 0x14140800, 0x24241c14, 0x382c24, 0x4801a80
.long 0x14140800, 0x24241c14, 0x382c24, 0x4801aa4
.long 0x14140800, 0x24241c14, 0x382c24, 0x4801ac8
.long 0x14140800, 0x24241c14, 0x382c24, 0x4801aec
.long 0x14140800, 0x24241c14, 0x382c24, 0x4800b60
.long 0x14140800, 0x24241c14, 0x382c24, 0x4800b84
.long 0x14140800, 0x24241c14, 0x382c24, 0x4800ba8
.long 0x14140800, 0x24241c14, 0x382c24, 0x4800bcc
.long 0x14140800, 0x24241c14, 0x382c24, 0x4800bf0
.long 0x14140800, 0x24241c14, 0x382c24, 0x4800c14
.long 0x14140800, 0x24241c14, 0x382c24, 0x4800c38
.long 0x14140800, 0x24241c14, 0x382c24, 0x4800c5c
.long 0x14140800, 0x24241c14, 0x382c24, 0x4800c80
.long 0x14140800, 0x24241c14, 0x382c24, 0x4800ca4
.long 0x14140800, 0x24241c14, 0x382c24, 0x4800cc8
.long 0x14140800, 0x24241c14, 0x382c24, 0x4800cec
.long 0x14140800, 0x24241c14, 0x382c24, 0x4800d10
.long 0x14140800, 0x24241c14, 0x382c24, 0x4800d34
.long 0x14140800, 0x24241c14, 0x382c24, 0x4800d58
.long 0x140c0804, 0x24241c14, 0x382c24, 0x4800d7c
.long 0x140c0804, 0x24201c18, 0x302c28, 0x41454
.long 0x140c0804, 0x24201c18, 0x302c28, 0x41478
.long 0x140c0804, 0x24201c18, 0x302c28, 0x4149c
.long 0x140c0804, 0x24201c18, 0x302c28, 0x414c0
.long 0x140c0804, 0x24201c18, 0x302c28, 0x414e4
.long 0x140c0804, 0x24201c18, 0x302c28, 0x41508
.long 0x140c0804, 0x24201c18, 0x302c28, 0x4152c
.long 0x140c0804, 0x24201c18, 0x302c28, 0x41550
.long 0x140c0804, 0x24201c18, 0x302c28, 0x41574
.long 0x140c0804, 0x24201c18, 0x302c28, 0x41598
.long 0x140c0804, 0x24201c18, 0x302c28, 0x415bc
.long 0x140c0804, 0x24201c18, 0x302c28, 0x415e0
.long 0x140c0804, 0x24201c18, 0x302c28, 0x41604
.long 0x140c0804, 0x24201c18, 0x302c28, 0x41628
.long 0x140c0804, 0x24201c18, 0x302c28, 0x4164c
.long 0x140c0804, 0x24201c18, 0x302c28, 0x41670
.long 0x140c0804, 0x24201c18, 0x302c28, 0x41454
.long 0x140c0804, 0x24201c18, 0x302c28, 0x41478
.long 0x140c0804, 0x24201c18, 0x302c28, 0x4149c
.long 0x140c0804, 0x24201c18, 0x302c28, 0x414c0
.long 0x140c0804, 0x24201c18, 0x302c28, 0x414e4
.long 0x140c0804, 0x24201c18, 0x302c28, 0x41508
.long 0x140c0804, 0x24201c18, 0x302c28, 0x4152c
.long 0x140c0804, 0x24201c18, 0x302c28, 0x41550
.long 0x140c0804, 0x24201c18, 0x302c28, 0x41574
.long 0x140c0804, 0x24201c18, 0x302c28, 0x41598
.long 0x140c0804, 0x24201c18, 0x302c28, 0x415bc
.long 0x140c0804, 0x24201c18, 0x302c28, 0x415e0
.long 0x140c0804, 0x24201c18, 0x302c28, 0x41604
.long 0x140c0804, 0x24201c18, 0x302c28, 0x41628
.long 0x140c0804, 0x24201c18, 0x302c28, 0x4164c
.long 0x140c0804, 0x24201c18, 0x302c28, 0x41670
.size lag_table, 4096
.section .rodata,"a"
.p2align 6
.amdhsa_kernel adaLN_cond__ssm_conv_s4__glu_gated_bilinear__prompt_kernel
  .amdhsa_next_free_vgpr 256
  .amdhsa_next_free_sgpr 102
  .amdhsa_accum_offset 256
  .amdhsa_group_segment_fixed_size 0
  .amdhsa_kernarg_size 144
  .amdhsa_user_sgpr_count 2
  .amdhsa_user_sgpr_kernarg_segment_ptr 1
  .amdhsa_system_sgpr_workgroup_id_x 1
  .amdhsa_float_denorm_mode_32 3
.end_amdhsa_kernel
```
